```python
import torch

def _softmax(x, axis=-1):
    return torch.softmax(x, dim=axis)
def _gelu(x):
    return torch.nn.functional.gelu(x, approximate="tanh")
def _silu(x):
    return torch.nn.functional.silu(x)
def _sigmoid(x):
    return torch.sigmoid(x)
def _layernorm(x, axis=-1, eps=1e-5):
    m = x.mean(dim=axis, keepdim=True)
    v = x.var(dim=axis, keepdim=True, unbiased=False)
    return (x - m) / torch.sqrt(v + eps)
def _scatter_add(tgt, idx, src, axis=0):
    return tgt.clone().index_add_(axis, idx, src)
def _segment_sum(src, seg, n):
    out = torch.zeros((n,) + src.shape[1:], dtype=src.dtype)
    return out.index_add_(0, seg, src)
def _pad(x, pw):
    flat = tuple(v for pair in reversed(pw) for v in pair)
    return torch.nn.functional.pad(x, flat)

kernel_name = 'recurrent_scan__sliding_block__glu_gated_bilinear__prompt'

def setup_inputs():

    _w = (lambda a: (lambda t: t.to(torch.bfloat16) if t.is_floating_point() else t)(torch.as_tensor(a)))
    def _A_setup():
        B, S, D = 1, 2048, 448
        return {
            "x": _w((lambda *s: torch.randn(*s, dtype=torch.bfloat16) * 0.05)(B, S, D)),
            "wqkv": _w((lambda *s: torch.randn(*s, dtype=torch.bfloat16) * 0.2)(D, 3 * D)),
            "wo": _w((lambda *s: torch.randn(*s, dtype=torch.bfloat16) * 0.2)(D, D)),
        }
    _A_in = _A_setup()

    def _B_setup():
        B, S, D, F = 1, 2048, 448, 1792
        return {
            "x": _w((lambda *s: torch.randn(*s, dtype=torch.bfloat16) * 0.05)(B, S, D)),
            "w_gate": _w((lambda *s: torch.randn(*s, dtype=torch.bfloat16) * 0.1)(D, F) * (D ** -0.5)),
            "w_up": _w((lambda *s: torch.randn(*s, dtype=torch.bfloat16) * 0.1)(D, F) * (D ** -0.5)),
            "w_down": _w((lambda *s: torch.randn(*s, dtype=torch.bfloat16) * 0.1)(F, D) * (F ** -0.5)),
        }
    _B_in = _B_setup()

    return {
        "A_x": _A_in["x"],
        "A_wqkv": _A_in["wqkv"],
        "A_wo": _A_in["wo"],
        "B_x": _B_in["x"],
        "B_w_gate": _B_in["w_gate"],
        "B_w_up": _B_in["w_up"],
        "B_w_down": _B_in["w_down"],
    }

def reference(A_x, A_wqkv, A_wo, B_x, B_w_gate, B_w_up, B_w_down):
    def _A_ref(x, wqkv, wo):
        B, S, D = x.shape
        H = 16; Dh = D // H; W = 256
        qkv = (lambda x, *d: x.permute(*d))((x @ wqkv).reshape(B, S, 3, H, Dh), 2, 0, 3, 1, 4)
        q, k, v = qkv[0], qkv[1], qkv[2]
        scores = torch.einsum("bhqd,bhkd->bhqk", q, k) * (Dh ** -0.5)
        idx = torch.arange(S)
        mask = (idx[:, None] - idx[None, :] >= 0) & (idx[:, None] - idx[None, :] < W)
        scores = torch.where(mask[None, None], scores, -1e9)
        p = _softmax(scores, axis=-1)
        o = torch.einsum("bhqk,bhkd->bhqd", p, v)
        return (lambda x, *d: x.permute(*d))(o, 0, 2, 1, 3).reshape(B, S, D) @ wo

    def _B_ref(x, w_gate, w_up, w_down):
        g = torch.einsum("bsd,df->bsf", x, w_gate)
        u = torch.einsum("bsd,df->bsf", x, w_up)
        h = g * u
        return torch.einsum("bsf,fd->bsd", h, w_down)

    x = A_x
    xn = _layernorm(x, axis=-1)
    s = _A_ref(xn, A_wqkv, A_wo)
    g = _silu(_B_ref(xn, B_w_gate, B_w_up, B_w_down))
    return x + s * g
```

```asm
; @launch grid=(256,1,1) block=(512,1,1) lds=159296
.amdgcn_target "amdgcn-amd-amdhsa--gfx950"
.text
.globl recurrent_scan__sliding_block__glu_gated_bilinear__prompt_kernel
.p2align 8
.type recurrent_scan__sliding_block__glu_gated_bilinear__prompt_kernel,@function
recurrent_scan__sliding_block__glu_gated_bilinear__prompt_kernel:
L_code_start:
    s_cmp_ge_u32 s2, 256
    s_cbranch_scc1 L_exit
    s_load_dwordx16 s[4:19], s[0:1], 0
    s_load_dwordx4 s[20:23], s[0:1], 64
    v_mov_b32 v255, 0
    v_and_b32 v1, 63, v0
    v_lshrrev_b32 v12, 6, v0
    v_lshrrev_b32 v2, 5, v1
    v_and_b32 v3, 31, v1
    v_readfirstlane_b32 s46, v12
    s_and_b32 s49, s2, 7
    s_lshr_b32 s50, s2, 3
    s_and_b32 s44, s49, 3
    s_lshl_b32 s44, s44, 2
    s_and_b32 s51, s50, 3
    s_add_u32 s44, s44, s51
    s_lshr_b32 s45, s49, 2
    s_lshl_b32 s45, s45, 3
    s_lshr_b32 s51, s50, 2
    s_add_u32 s45, s45, s51
    s_lshl_b32 s94, s45, 4
    s_add_u32 s94, s94, s44
    s_and_b32 s47, s46, 3
    s_lshr_b32 s48, s46, 2
    s_lshl_b32 s49, s45, 7
    s_lshl_b32 s50, s46, 4
    s_add_u32 s49, s49, s50
    v_lshrrev_b32 v12, 3, v1
    v_add_u32 v4, s49, v12
    v_mul_u32_u24 v4, 896, v4
    v_and_b32 v13, 7, v1
    v_lshl_add_u32 v4, v13, 4, v4
    v_add_u32 v9, 7168, v4
    s_waitcnt lgkmcnt(0)
    s_mov_b32 s24, s4
    s_and_b32 s25, s5, 0xffff
    s_mov_b32 s26, 0x1c0000
    s_mov_b32 s27, 0x00020000
    buffer_load_dwordx4 v[128:131], v4, s[24:27], 0 offen offset:0
    buffer_load_dwordx4 v[132:135], v4, s[24:27], 0 offen offset:128
    buffer_load_dwordx4 v[136:139], v4, s[24:27], 0 offen offset:256
    buffer_load_dwordx4 v[140:143], v4, s[24:27], 0 offen offset:384
    buffer_load_dwordx4 v[144:147], v4, s[24:27], 0 offen offset:512
    buffer_load_dwordx4 v[148:151], v4, s[24:27], 0 offen offset:640
    buffer_load_dwordx4 v[152:155], v4, s[24:27], 0 offen offset:768
    buffer_load_dwordx4 v[156:159], v9, s[24:27], 0 offen offset:0
    buffer_load_dwordx4 v[160:163], v9, s[24:27], 0 offen offset:128
    buffer_load_dwordx4 v[164:167], v9, s[24:27], 0 offen offset:256
    buffer_load_dwordx4 v[168:171], v9, s[24:27], 0 offen offset:384
    buffer_load_dwordx4 v[172:175], v9, s[24:27], 0 offen offset:512
    buffer_load_dwordx4 v[176:179], v9, s[24:27], 0 offen offset:640
    buffer_load_dwordx4 v[180:183], v9, s[24:27], 0 offen offset:768
    s_lshr_b32 s49, s2, 3
    s_lshl_b32 s49, s49, 3
    s_add_u32 s49, s49, s46
    s_lshl_b32 s49, s49, 10
    s_cmp_ge_u32 s49, L_code_end - L_code_start
    s_cbranch_scc1 L_cpf_1
    s_getpc_b64 s[50:51]
L_pc_here:
    s_sub_u32 s50, s50, L_pc_here - L_code_start
    s_subb_u32 s51, s51, 0
    v_lshlrev_b32 v12, 4, v1
    v_add_u32 v12, s49, v12
    global_load_dwordx4 v[244:247], v12, s[50:51]
L_cpf_1:
    s_mov_b32 s28, s6
    s_and_b32 s29, s7, 0xffff
    s_mov_b32 s30, 0x126000
    s_mov_b32 s31, 0x00020000
    s_mov_b32 s32, s12
    s_and_b32 s33, s13, 0xffff
    s_mov_b32 s34, 0x188000
    s_mov_b32 s35, 0x00020000
    s_mov_b32 s36, s14
    s_and_b32 s37, s15, 0xffff
    s_mov_b32 s38, 0x188000
    s_mov_b32 s39, 0x00020000
    s_mov_b32 s40, s22
    s_and_b32 s41, s23, 0xffff
    s_mov_b32 s42, 0x1000000
    s_mov_b32 s43, 0x00020000
    s_mov_b32 s84, s20
    s_and_b32 s85, s21, 0xffff
    s_mov_b32 s86, 0x100
    s_mov_b32 s87, 0x00020000
    s_mov_b32 s96, s22
    s_and_b32 s97, s23, 0xffff
    s_mov_b32 s98, 0x2000000
    s_mov_b32 s99, 0x00020000
    s_cmp_lg_u32 s46, 0
    s_cbranch_scc1 L_non_2
    s_memrealtime s[90:91]
    s_waitcnt lgkmcnt(0)
    s_or_b32 s90, s90, 1
    v_mov_b32 v248, s90
    v_mov_b32 v249, s91
    v_mov_b32 v250, 0
    v_mov_b32 v251, 0
    v_mov_b32 v252, 0
    s_mov_b64 exec, 1
    buffer_atomic_cmpswap_x2 v[248:251], v252, s[84:87], 0 offen sc0
    s_mov_b64 exec, -1
L_non_2:
    s_mov_b32 s52, -1
    s_mov_b32 s53, 0xffff
    s_mov_b32 s54, -1
    s_mov_b32 s55, 0xffffff
    s_mov_b32 s56, 0x00003f80
    s_mov_b32 s57, 0x3f800000
    s_mov_b32 s58, 0xffff0000
    s_mul_i32 s59, s46, 1536
    s_mul_i32 s60, s46, 896
    v_mul_u32_u24 v12, 43, v1
    v_lshrrev_b32 v12, 9, v12
    v_mul_u32_u24 v13, 12, v12
    v_sub_u32 v13, v1, v13
    s_lshl_b32 s49, s46, 3
    v_add_u32 v12, s49, v12
    v_mul_u32_u24 v5, 2688, v12
    v_lshl_add_u32 v5, v13, 4, v5
    s_mul_i32 s49, s44, 168
    v_add_u32 v5, s49, v5
    v_mul_u32_u24 v12, 37, v1
    v_lshrrev_b32 v12, 9, v12
    v_mul_u32_u24 v13, 14, v12
    v_sub_u32 v13, v1, v13
    s_lshl_b32 s49, s46, 2
    v_add_u32 v12, s49, v12
    v_mul_u32_u24 v6, 3584, v12
    v_lshl_add_u32 v6, v13, 4, v6
    s_mul_i32 s49, s44, 224
    v_add_u32 v6, s49, v6
    v_and_b32 v12, 15, v1
    v_lshrrev_b32 v13, 2, v12
    v_lshl_add_u32 v13, v2, 3, v13
    v_and_b32 v12, 3, v12
    v_lshlrev_b32 v12, 3, v12
    v_bfe_u32 v14, v1, 4, 1
    v_mul_u32_u24 v7, 192, v13
    v_add_u32 v7, v7, v12
    v_lshl_add_u32 v7, v14, 5, v7
    v_mul_u32_u24 v8, 224, v13
    v_add_u32 v8, v8, v12
    v_mul_u32_u24 v14, 7296, v14
    v_add_u32 v8, v8, v14
    s_lshl_b32 s49, s45, 7
    s_lshl_b32 s50, s47, 5
    s_add_u32 s49, s49, s50
    v_add_u32 v12, s49, v3
    v_lshrrev_b32 v13, 4, v12
    v_lshlrev_b32 v240, 10, v13
    v_and_b32 v13, 15, v12
    v_lshl_add_u32 v240, v13, 4, v240
    v_lshl_add_u32 v240, v2, 9, v240
    s_lshl_b32 s49, s45, 2
    s_add_u32 s49, s49, s47
    s_mul_i32 s51, s49, 112
    s_mul_i32 s50, s44, 7
    s_add_u32 s51, s51, s50
    s_lshl_b32 s51, s51, 10
    s_add_u32 s51, s51, 6291456
    v_lshlrev_b32 v242, 4, v1
    v_add_u32 v242, s51, v242
    v_cmp_le_u32 s[62:63], 32, v1
    v_mov_b32 v236, s58
    s_mov_b32 s49, 0x3f803f80
    s_waitcnt vmcnt(13)
    v_dot2_f32_bf16 v224, v128, s49, 0
    v_dot2_f32_bf16 v226, v128, v128, 0
    v_dot2_f32_bf16 v225, v129, s49, 0
    v_dot2_f32_bf16 v227, v129, v129, 0
    v_dot2_f32_bf16 v224, v130, s49, v224
    v_dot2_f32_bf16 v226, v130, v130, v226
    v_dot2_f32_bf16 v225, v131, s49, v225
    v_dot2_f32_bf16 v227, v131, v131, v227
    s_waitcnt vmcnt(12)
    v_dot2_f32_bf16 v224, v132, s49, v224
    v_dot2_f32_bf16 v226, v132, v132, v226
    v_dot2_f32_bf16 v225, v133, s49, v225
    v_dot2_f32_bf16 v227, v133, v133, v227
    v_dot2_f32_bf16 v224, v134, s49, v224
    v_dot2_f32_bf16 v226, v134, v134, v226
    v_dot2_f32_bf16 v225, v135, s49, v225
    v_dot2_f32_bf16 v227, v135, v135, v227
    s_waitcnt vmcnt(11)
    v_dot2_f32_bf16 v224, v136, s49, v224
    v_dot2_f32_bf16 v226, v136, v136, v226
    v_dot2_f32_bf16 v225, v137, s49, v225
    v_dot2_f32_bf16 v227, v137, v137, v227
    v_dot2_f32_bf16 v224, v138, s49, v224
    v_dot2_f32_bf16 v226, v138, v138, v226
    v_dot2_f32_bf16 v225, v139, s49, v225
    v_dot2_f32_bf16 v227, v139, v139, v227
    s_waitcnt vmcnt(10)
    v_dot2_f32_bf16 v224, v140, s49, v224
    v_dot2_f32_bf16 v226, v140, v140, v226
    v_dot2_f32_bf16 v225, v141, s49, v225
    v_dot2_f32_bf16 v227, v141, v141, v227
    v_dot2_f32_bf16 v224, v142, s49, v224
    v_dot2_f32_bf16 v226, v142, v142, v226
    v_dot2_f32_bf16 v225, v143, s49, v225
    v_dot2_f32_bf16 v227, v143, v143, v227
    s_waitcnt vmcnt(9)
    v_dot2_f32_bf16 v224, v144, s49, v224
    v_dot2_f32_bf16 v226, v144, v144, v226
    v_dot2_f32_bf16 v225, v145, s49, v225
    v_dot2_f32_bf16 v227, v145, v145, v227
    v_dot2_f32_bf16 v224, v146, s49, v224
    v_dot2_f32_bf16 v226, v146, v146, v226
    v_dot2_f32_bf16 v225, v147, s49, v225
    v_dot2_f32_bf16 v227, v147, v147, v227
    s_waitcnt vmcnt(8)
    v_dot2_f32_bf16 v224, v148, s49, v224
    v_dot2_f32_bf16 v226, v148, v148, v226
    v_dot2_f32_bf16 v225, v149, s49, v225
    v_dot2_f32_bf16 v227, v149, v149, v227
    v_dot2_f32_bf16 v224, v150, s49, v224
    v_dot2_f32_bf16 v226, v150, v150, v226
    v_dot2_f32_bf16 v225, v151, s49, v225
    v_dot2_f32_bf16 v227, v151, v151, v227
    s_waitcnt vmcnt(7)
    v_dot2_f32_bf16 v224, v152, s49, v224
    v_dot2_f32_bf16 v226, v152, v152, v226
    v_dot2_f32_bf16 v225, v153, s49, v225
    v_dot2_f32_bf16 v227, v153, v153, v227
    v_dot2_f32_bf16 v224, v154, s49, v224
    v_dot2_f32_bf16 v226, v154, v154, v226
    v_dot2_f32_bf16 v225, v155, s49, v225
    v_dot2_f32_bf16 v227, v155, v155, v227
    s_waitcnt vmcnt(6)
    v_dot2_f32_bf16 v228, v156, s49, 0
    v_dot2_f32_bf16 v230, v156, v156, 0
    v_dot2_f32_bf16 v229, v157, s49, 0
    v_dot2_f32_bf16 v231, v157, v157, 0
    v_dot2_f32_bf16 v228, v158, s49, v228
    v_dot2_f32_bf16 v230, v158, v158, v230
    v_dot2_f32_bf16 v229, v159, s49, v229
    v_dot2_f32_bf16 v231, v159, v159, v231
    s_waitcnt vmcnt(5)
    v_dot2_f32_bf16 v228, v160, s49, v228
    v_dot2_f32_bf16 v230, v160, v160, v230
    v_dot2_f32_bf16 v229, v161, s49, v229
    v_dot2_f32_bf16 v231, v161, v161, v231
    v_dot2_f32_bf16 v228, v162, s49, v228
    v_dot2_f32_bf16 v230, v162, v162, v230
    v_dot2_f32_bf16 v229, v163, s49, v229
    v_dot2_f32_bf16 v231, v163, v163, v231
    s_waitcnt vmcnt(4)
    v_dot2_f32_bf16 v228, v164, s49, v228
    v_dot2_f32_bf16 v230, v164, v164, v230
    v_dot2_f32_bf16 v229, v165, s49, v229
    v_dot2_f32_bf16 v231, v165, v165, v231
    v_dot2_f32_bf16 v228, v166, s49, v228
    v_dot2_f32_bf16 v230, v166, v166, v230
    v_dot2_f32_bf16 v229, v167, s49, v229
    v_dot2_f32_bf16 v231, v167, v167, v231
    s_waitcnt vmcnt(3)
    v_dot2_f32_bf16 v228, v168, s49, v228
    v_dot2_f32_bf16 v230, v168, v168, v230
    v_dot2_f32_bf16 v229, v169, s49, v229
    v_dot2_f32_bf16 v231, v169, v169, v231
    v_dot2_f32_bf16 v228, v170, s49, v228
    v_dot2_f32_bf16 v230, v170, v170, v230
    v_dot2_f32_bf16 v229, v171, s49, v229
    v_dot2_f32_bf16 v231, v171, v171, v231
    s_waitcnt vmcnt(2)
    v_dot2_f32_bf16 v228, v172, s49, v228
    v_dot2_f32_bf16 v230, v172, v172, v230
    v_dot2_f32_bf16 v229, v173, s49, v229
    v_dot2_f32_bf16 v231, v173, v173, v231
    v_dot2_f32_bf16 v228, v174, s49, v228
    v_dot2_f32_bf16 v230, v174, v174, v230
    v_dot2_f32_bf16 v229, v175, s49, v229
    v_dot2_f32_bf16 v231, v175, v175, v231
    s_waitcnt vmcnt(1)
    v_dot2_f32_bf16 v228, v176, s49, v228
    v_dot2_f32_bf16 v230, v176, v176, v230
    v_dot2_f32_bf16 v229, v177, s49, v229
    v_dot2_f32_bf16 v231, v177, v177, v231
    v_dot2_f32_bf16 v228, v178, s49, v228
    v_dot2_f32_bf16 v230, v178, v178, v230
    v_dot2_f32_bf16 v229, v179, s49, v229
    v_dot2_f32_bf16 v231, v179, v179, v231
    s_waitcnt vmcnt(0)
    v_dot2_f32_bf16 v228, v180, s49, v228
    v_dot2_f32_bf16 v230, v180, v180, v230
    v_dot2_f32_bf16 v229, v181, s49, v229
    v_dot2_f32_bf16 v231, v181, v181, v231
    v_dot2_f32_bf16 v228, v182, s49, v228
    v_dot2_f32_bf16 v230, v182, v182, v230
    v_dot2_f32_bf16 v229, v183, s49, v229
    v_dot2_f32_bf16 v231, v183, v183, v231
    v_add_f32 v224, v224, v225
    v_add_f32 v226, v226, v227
    v_add_f32 v228, v228, v229
    v_add_f32 v230, v230, v231
    v_add_f32_dpp v224, v224, v224 quad_perm:[1,0,3,2] row_mask:0xf bank_mask:0xf
    v_add_f32_dpp v226, v226, v226 quad_perm:[1,0,3,2] row_mask:0xf bank_mask:0xf
    v_add_f32_dpp v228, v228, v228 quad_perm:[1,0,3,2] row_mask:0xf bank_mask:0xf
    v_add_f32_dpp v230, v230, v230 quad_perm:[1,0,3,2] row_mask:0xf bank_mask:0xf
    v_add_f32_dpp v224, v224, v224 quad_perm:[2,3,0,1] row_mask:0xf bank_mask:0xf
    v_add_f32_dpp v226, v226, v226 quad_perm:[2,3,0,1] row_mask:0xf bank_mask:0xf
    v_add_f32_dpp v228, v228, v228 quad_perm:[2,3,0,1] row_mask:0xf bank_mask:0xf
    v_add_f32_dpp v230, v230, v230 quad_perm:[2,3,0,1] row_mask:0xf bank_mask:0xf
    v_add_f32_dpp v224, v224, v224 row_half_mirror row_mask:0xf bank_mask:0xf
    v_add_f32_dpp v226, v226, v226 row_half_mirror row_mask:0xf bank_mask:0xf
    v_add_f32_dpp v228, v228, v228 row_half_mirror row_mask:0xf bank_mask:0xf
    v_add_f32_dpp v230, v230, v230 row_half_mirror row_mask:0xf bank_mask:0xf
    v_mul_u32_u24 v16, 43, v1
    v_lshrrev_b32 v16, 7, v16
    v_mul_u32_u24 v17, 3, v16
    v_sub_u32 v17, v1, v17
    s_mul_i32 s49, s46, 7
    v_add_u32 v16, s49, v16
    v_lshlrev_b32 v16, 3, v16
    s_and_b32 s49, s45, 7
    v_add_u32 v16, s49, v16
    v_lshlrev_b32 v17, 7, v17
    v_min_u32 v18, 0xb8, v17
    v_mul_u32_u24 v19, 2688, v16
    v_add_u32 v18, v18, v19
    s_mul_i32 s49, s44, 168
    v_add_u32 v18, s49, v18
    v_min_u32 v17, 0xd8, v17
    v_mul_u32_u24 v19, 3584, v16
    v_add_u32 v17, v17, v19
    s_mul_i32 s49, s44, 224
    v_add_u32 v17, s49, v17
    s_mov_b64 exec, 0x1fffff
    buffer_load_dword v244, v18, s[28:31], 0 offen
    buffer_load_dword v245, v17, s[32:35], 0 offen
    buffer_load_dword v246, v17, s[36:39], 0 offen
    s_mov_b64 exec, -1
    s_mov_b32 s49, 0x3b124925
    v_mul_f32 v224, s49, v224
    v_mul_f32 v226, s49, v226
    v_fma_f32 v226, -v224, v224, v226
    v_max_f32 v226, 0, v226
    v_cvt_pk_bf16_f32 v225, v224, v226
    v_lshlrev_b32 v224, 16, v225
    v_and_b32 v226, s58, v225
    v_xor_b32 v10, 0x80000000, v224
    v_add_f32 v226, 0x3727c5ac, v226
    v_cvt_pk_bf16_f32 v226, v226, v226
    v_and_b32 v226, s58, v226
    v_sqrt_f32 v226, v226
    s_nop 0
    v_cvt_pk_bf16_f32 v226, v226, v226
    v_and_b32 v226, s58, v226
    v_rcp_f32 v11, v226
    s_nop 0
    v_fma_f32 v227, -v226, v11, 2.0
    v_mul_f32 v11, v11, v227
    v_mul_f32 v228, s49, v228
    v_mul_f32 v230, s49, v230
    v_fma_f32 v230, -v228, v228, v230
    v_max_f32 v230, 0, v230
    v_cvt_pk_bf16_f32 v229, v228, v230
    v_lshlrev_b32 v228, 16, v229
    v_and_b32 v230, s58, v229
    v_xor_b32 v12, 0x80000000, v228
    v_add_f32 v230, 0x3727c5ac, v230
    v_cvt_pk_bf16_f32 v230, v230, v230
    v_and_b32 v230, s58, v230
    v_sqrt_f32 v230, v230
    s_nop 0
    v_cvt_pk_bf16_f32 v230, v230, v230
    v_and_b32 v230, s58, v230
    v_rcp_f32 v13, v230
    s_nop 0
    v_fma_f32 v231, -v230, v13, 2.0
    v_mul_f32 v13, v13, v231
    s_lshr_b32 s49, s46, 1
    s_mul_i32 s49, s49, 28672
    s_and_b32 s50, s46, 1
    s_lshl_b32 s50, s50, 4
    v_lshrrev_b32 v14, 3, v1
    v_add_u32 v14, s50, v14
    v_and_b32 v15, 7, v1
    v_xor_b32 v14, v14, v15
    v_lshlrev_b32 v14, 4, v14
    v_lshrrev_b32 v9, 1, v15
    v_lshl_add_u32 v14, v9, 10, v14
    v_and_b32 v9, 1, v15
    v_lshl_add_u32 v14, v9, 9, v14
    v_add_u32 v14, s49, v14
    s_mov_b64 exec, s[52:53]
    s_add_u32 m0, s59, 114688
    s_mov_b32 s50, 0
    buffer_load_dwordx4 v5, s[28:31], s50 offen lds
    s_add_u32 m0, s59, 115456
    s_mov_b32 s50, 10752
    buffer_load_dwordx4 v5, s[28:31], s50 offen lds
    s_mov_b64 exec, -1
    v_dot2_f32_bf16 v224, v128, s56, v10
    v_dot2_f32_bf16 v225, v128, s57, v10
    v_dot2_f32_bf16 v226, v129, s56, v10
    v_dot2_f32_bf16 v227, v129, s57, v10
    v_dot2_f32_bf16 v228, v130, s56, v10
    v_dot2_f32_bf16 v229, v130, s57, v10
    v_dot2_f32_bf16 v230, v131, s56, v10
    v_dot2_f32_bf16 v231, v131, s57, v10
    v_cvt_pk_bf16_f32 v232, v224, v225
    v_cvt_pk_bf16_f32 v233, v226, v227
    v_cvt_pk_bf16_f32 v234, v228, v229
    v_cvt_pk_bf16_f32 v235, v230, v231
    v_lshlrev_b32 v224, 16, v232
    v_and_b32 v225, v236, v232
    v_lshlrev_b32 v226, 16, v233
    v_and_b32 v227, v236, v233
    v_lshlrev_b32 v228, 16, v234
    v_and_b32 v229, v236, v234
    v_lshlrev_b32 v230, 16, v235
    v_and_b32 v231, v236, v235
    v_mul_f32 v224, v224, v11
    v_mul_f32 v225, v225, v11
    v_mul_f32 v226, v226, v11
    v_mul_f32 v227, v227, v11
    v_mul_f32 v228, v228, v11
    v_mul_f32 v229, v229, v11
    v_mul_f32 v230, v230, v11
    v_mul_f32 v231, v231, v11
    v_cvt_pk_bf16_f32 v128, v224, v225
    v_cvt_pk_bf16_f32 v129, v226, v227
    v_cvt_pk_bf16_f32 v130, v228, v229
    v_cvt_pk_bf16_f32 v131, v230, v231
    ds_write_b128 v14, v[128:131] offset:0
    v_dot2_f32_bf16 v224, v132, s56, v10
    v_dot2_f32_bf16 v225, v132, s57, v10
    v_dot2_f32_bf16 v226, v133, s56, v10
    v_dot2_f32_bf16 v227, v133, s57, v10
    v_dot2_f32_bf16 v228, v134, s56, v10
    v_dot2_f32_bf16 v229, v134, s57, v10
    v_dot2_f32_bf16 v230, v135, s56, v10
    v_dot2_f32_bf16 v231, v135, s57, v10
    v_cvt_pk_bf16_f32 v232, v224, v225
    v_cvt_pk_bf16_f32 v233, v226, v227
    v_cvt_pk_bf16_f32 v234, v228, v229
    v_cvt_pk_bf16_f32 v235, v230, v231
    v_lshlrev_b32 v224, 16, v232
    v_and_b32 v225, v236, v232
    v_lshlrev_b32 v226, 16, v233
    v_and_b32 v227, v236, v233
    v_lshlrev_b32 v228, 16, v234
    v_and_b32 v229, v236, v234
    v_lshlrev_b32 v230, 16, v235
    v_and_b32 v231, v236, v235
    v_mul_f32 v224, v224, v11
    v_mul_f32 v225, v225, v11
    v_mul_f32 v226, v226, v11
    v_mul_f32 v227, v227, v11
    v_mul_f32 v228, v228, v11
    v_mul_f32 v229, v229, v11
    v_mul_f32 v230, v230, v11
    v_mul_f32 v231, v231, v11
    v_cvt_pk_bf16_f32 v132, v224, v225
    v_cvt_pk_bf16_f32 v133, v226, v227
    v_cvt_pk_bf16_f32 v134, v228, v229
    v_cvt_pk_bf16_f32 v135, v230, v231
    ds_write_b128 v14, v[132:135] offset:4096
    v_dot2_f32_bf16 v224, v136, s56, v10
    v_dot2_f32_bf16 v225, v136, s57, v10
    v_dot2_f32_bf16 v226, v137, s56, v10
    v_dot2_f32_bf16 v227, v137, s57, v10
    v_dot2_f32_bf16 v228, v138, s56, v10
    v_dot2_f32_bf16 v229, v138, s57, v10
    v_dot2_f32_bf16 v230, v139, s56, v10
    v_dot2_f32_bf16 v231, v139, s57, v10
    v_cvt_pk_bf16_f32 v232, v224, v225
    v_cvt_pk_bf16_f32 v233, v226, v227
    v_cvt_pk_bf16_f32 v234, v228, v229
    v_cvt_pk_bf16_f32 v235, v230, v231
    v_lshlrev_b32 v224, 16, v232
    v_and_b32 v225, v236, v232
    v_lshlrev_b32 v226, 16, v233
    v_and_b32 v227, v236, v233
    v_lshlrev_b32 v228, 16, v234
    v_and_b32 v229, v236, v234
    v_lshlrev_b32 v230, 16, v235
    v_and_b32 v231, v236, v235
    v_mul_f32 v224, v224, v11
    v_mul_f32 v225, v225, v11
    v_mul_f32 v226, v226, v11
    v_mul_f32 v227, v227, v11
    v_mul_f32 v228, v228, v11
    v_mul_f32 v229, v229, v11
    v_mul_f32 v230, v230, v11
    v_mul_f32 v231, v231, v11
    v_cvt_pk_bf16_f32 v136, v224, v225
    v_cvt_pk_bf16_f32 v137, v226, v227
    v_cvt_pk_bf16_f32 v138, v228, v229
    v_cvt_pk_bf16_f32 v139, v230, v231
    ds_write_b128 v14, v[136:139] offset:8192
    s_mov_b64 exec, s[52:53]
    s_add_u32 m0, s59, 129536
    s_mov_b32 s50, 172032
    buffer_load_dwordx4 v5, s[28:31], s50 offen lds
    s_add_u32 m0, s59, 130304
    s_mov_b32 s50, 182784
    buffer_load_dwordx4 v5, s[28:31], s50 offen lds
    s_mov_b64 exec, -1
    v_dot2_f32_bf16 v224, v140, s56, v10
    v_dot2_f32_bf16 v225, v140, s57, v10
    v_dot2_f32_bf16 v226, v141, s56, v10
    v_dot2_f32_bf16 v227, v141, s57, v10
    v_dot2_f32_bf16 v228, v142, s56, v10
    v_dot2_f32_bf16 v229, v142, s57, v10
    v_dot2_f32_bf16 v230, v143, s56, v10
    v_dot2_f32_bf16 v231, v143, s57, v10
    v_cvt_pk_bf16_f32 v232, v224, v225
    v_cvt_pk_bf16_f32 v233, v226, v227
    v_cvt_pk_bf16_f32 v234, v228, v229
    v_cvt_pk_bf16_f32 v235, v230, v231
    v_lshlrev_b32 v224, 16, v232
    v_and_b32 v225, v236, v232
    v_lshlrev_b32 v226, 16, v233
    v_and_b32 v227, v236, v233
    v_lshlrev_b32 v228, 16, v234
    v_and_b32 v229, v236, v234
    v_lshlrev_b32 v230, 16, v235
    v_and_b32 v231, v236, v235
    v_mul_f32 v224, v224, v11
    v_mul_f32 v225, v225, v11
    v_mul_f32 v226, v226, v11
    v_mul_f32 v227, v227, v11
    v_mul_f32 v228, v228, v11
    v_mul_f32 v229, v229, v11
    v_mul_f32 v230, v230, v11
    v_mul_f32 v231, v231, v11
    v_cvt_pk_bf16_f32 v140, v224, v225
    v_cvt_pk_bf16_f32 v141, v226, v227
    v_cvt_pk_bf16_f32 v142, v228, v229
    v_cvt_pk_bf16_f32 v143, v230, v231
    ds_write_b128 v14, v[140:143] offset:12288
    v_dot2_f32_bf16 v224, v144, s56, v10
    v_dot2_f32_bf16 v225, v144, s57, v10
    v_dot2_f32_bf16 v226, v145, s56, v10
    v_dot2_f32_bf16 v227, v145, s57, v10
    v_dot2_f32_bf16 v228, v146, s56, v10
    v_dot2_f32_bf16 v229, v146, s57, v10
    v_dot2_f32_bf16 v230, v147, s56, v10
    v_dot2_f32_bf16 v231, v147, s57, v10
    v_cvt_pk_bf16_f32 v232, v224, v225
    v_cvt_pk_bf16_f32 v233, v226, v227
    v_cvt_pk_bf16_f32 v234, v228, v229
    v_cvt_pk_bf16_f32 v235, v230, v231
    v_lshlrev_b32 v224, 16, v232
    v_and_b32 v225, v236, v232
    v_lshlrev_b32 v226, 16, v233
    v_and_b32 v227, v236, v233
    v_lshlrev_b32 v228, 16, v234
    v_and_b32 v229, v236, v234
    v_lshlrev_b32 v230, 16, v235
    v_and_b32 v231, v236, v235
    v_mul_f32 v224, v224, v11
    v_mul_f32 v225, v225, v11
    v_mul_f32 v226, v226, v11
    v_mul_f32 v227, v227, v11
    v_mul_f32 v228, v228, v11
    v_mul_f32 v229, v229, v11
    v_mul_f32 v230, v230, v11
    v_mul_f32 v231, v231, v11
    v_cvt_pk_bf16_f32 v144, v224, v225
    v_cvt_pk_bf16_f32 v145, v226, v227
    v_cvt_pk_bf16_f32 v146, v228, v229
    v_cvt_pk_bf16_f32 v147, v230, v231
    ds_write_b128 v14, v[144:147] offset:16384
    v_dot2_f32_bf16 v224, v148, s56, v10
    v_dot2_f32_bf16 v225, v148, s57, v10
    v_dot2_f32_bf16 v226, v149, s56, v10
    v_dot2_f32_bf16 v227, v149, s57, v10
    v_dot2_f32_bf16 v228, v150, s56, v10
    v_dot2_f32_bf16 v229, v150, s57, v10
    v_dot2_f32_bf16 v230, v151, s56, v10
    v_dot2_f32_bf16 v231, v151, s57, v10
    v_cvt_pk_bf16_f32 v232, v224, v225
    v_cvt_pk_bf16_f32 v233, v226, v227
    v_cvt_pk_bf16_f32 v234, v228, v229
    v_cvt_pk_bf16_f32 v235, v230, v231
    v_lshlrev_b32 v224, 16, v232
    v_and_b32 v225, v236, v232
    v_lshlrev_b32 v226, 16, v233
    v_and_b32 v227, v236, v233
    v_lshlrev_b32 v228, 16, v234
    v_and_b32 v229, v236, v234
    v_lshlrev_b32 v230, 16, v235
    v_and_b32 v231, v236, v235
    v_mul_f32 v224, v224, v11
    v_mul_f32 v225, v225, v11
    v_mul_f32 v226, v226, v11
    v_mul_f32 v227, v227, v11
    v_mul_f32 v228, v228, v11
    v_mul_f32 v229, v229, v11
    v_mul_f32 v230, v230, v11
    v_mul_f32 v231, v231, v11
    v_cvt_pk_bf16_f32 v148, v224, v225
    v_cvt_pk_bf16_f32 v149, v226, v227
    v_cvt_pk_bf16_f32 v150, v228, v229
    v_cvt_pk_bf16_f32 v151, v230, v231
    ds_write_b128 v14, v[148:151] offset:20480
    s_mov_b64 exec, s[52:53]
    s_add_u32 m0, s59, 144384
    s_mov_b32 s50, 344064
    buffer_load_dwordx4 v5, s[28:31], s50 offen lds
    s_add_u32 m0, s59, 145152
    s_mov_b32 s50, 354816
    buffer_load_dwordx4 v5, s[28:31], s50 offen lds
    s_mov_b64 exec, -1
    v_dot2_f32_bf16 v224, v152, s56, v10
    v_dot2_f32_bf16 v225, v152, s57, v10
    v_dot2_f32_bf16 v226, v153, s56, v10
    v_dot2_f32_bf16 v227, v153, s57, v10
    v_dot2_f32_bf16 v228, v154, s56, v10
    v_dot2_f32_bf16 v229, v154, s57, v10
    v_dot2_f32_bf16 v230, v155, s56, v10
    v_dot2_f32_bf16 v231, v155, s57, v10
    v_cvt_pk_bf16_f32 v232, v224, v225
    v_cvt_pk_bf16_f32 v233, v226, v227
    v_cvt_pk_bf16_f32 v234, v228, v229
    v_cvt_pk_bf16_f32 v235, v230, v231
    v_lshlrev_b32 v224, 16, v232
    v_and_b32 v225, v236, v232
    v_lshlrev_b32 v226, 16, v233
    v_and_b32 v227, v236, v233
    v_lshlrev_b32 v228, 16, v234
    v_and_b32 v229, v236, v234
    v_lshlrev_b32 v230, 16, v235
    v_and_b32 v231, v236, v235
    v_mul_f32 v224, v224, v11
    v_mul_f32 v225, v225, v11
    v_mul_f32 v226, v226, v11
    v_mul_f32 v227, v227, v11
    v_mul_f32 v228, v228, v11
    v_mul_f32 v229, v229, v11
    v_mul_f32 v230, v230, v11
    v_mul_f32 v231, v231, v11
    v_cvt_pk_bf16_f32 v152, v224, v225
    v_cvt_pk_bf16_f32 v153, v226, v227
    v_cvt_pk_bf16_f32 v154, v228, v229
    v_cvt_pk_bf16_f32 v155, v230, v231
    ds_write_b128 v14, v[152:155] offset:24576
    v_dot2_f32_bf16 v224, v156, s56, v12
    v_dot2_f32_bf16 v225, v156, s57, v12
    v_dot2_f32_bf16 v226, v157, s56, v12
    v_dot2_f32_bf16 v227, v157, s57, v12
    v_dot2_f32_bf16 v228, v158, s56, v12
    v_dot2_f32_bf16 v229, v158, s57, v12
    v_dot2_f32_bf16 v230, v159, s56, v12
    v_dot2_f32_bf16 v231, v159, s57, v12
    v_cvt_pk_bf16_f32 v232, v224, v225
    v_cvt_pk_bf16_f32 v233, v226, v227
    v_cvt_pk_bf16_f32 v234, v228, v229
    v_cvt_pk_bf16_f32 v235, v230, v231
    v_lshlrev_b32 v224, 16, v232
    v_and_b32 v225, v236, v232
    v_lshlrev_b32 v226, 16, v233
    v_and_b32 v227, v236, v233
    v_lshlrev_b32 v228, 16, v234
    v_and_b32 v229, v236, v234
    v_lshlrev_b32 v230, 16, v235
    v_and_b32 v231, v236, v235
    v_mul_f32 v224, v224, v13
    v_mul_f32 v225, v225, v13
    v_mul_f32 v226, v226, v13
    v_mul_f32 v227, v227, v13
    v_mul_f32 v228, v228, v13
    v_mul_f32 v229, v229, v13
    v_mul_f32 v230, v230, v13
    v_mul_f32 v231, v231, v13
    v_cvt_pk_bf16_f32 v156, v224, v225
    v_cvt_pk_bf16_f32 v157, v226, v227
    v_cvt_pk_bf16_f32 v158, v228, v229
    v_cvt_pk_bf16_f32 v159, v230, v231
    ds_write_b128 v14, v[156:159] offset:128
    v_dot2_f32_bf16 v224, v160, s56, v12
    v_dot2_f32_bf16 v225, v160, s57, v12
    v_dot2_f32_bf16 v226, v161, s56, v12
    v_dot2_f32_bf16 v227, v161, s57, v12
    v_dot2_f32_bf16 v228, v162, s56, v12
    v_dot2_f32_bf16 v229, v162, s57, v12
    v_dot2_f32_bf16 v230, v163, s56, v12
    v_dot2_f32_bf16 v231, v163, s57, v12
    v_cvt_pk_bf16_f32 v232, v224, v225
    v_cvt_pk_bf16_f32 v233, v226, v227
    v_cvt_pk_bf16_f32 v234, v228, v229
    v_cvt_pk_bf16_f32 v235, v230, v231
    v_lshlrev_b32 v224, 16, v232
    v_and_b32 v225, v236, v232
    v_lshlrev_b32 v226, 16, v233
    v_and_b32 v227, v236, v233
    v_lshlrev_b32 v228, 16, v234
    v_and_b32 v229, v236, v234
    v_lshlrev_b32 v230, 16, v235
    v_and_b32 v231, v236, v235
    v_mul_f32 v224, v224, v13
    v_mul_f32 v225, v225, v13
    v_mul_f32 v226, v226, v13
    v_mul_f32 v227, v227, v13
    v_mul_f32 v228, v228, v13
    v_mul_f32 v229, v229, v13
    v_mul_f32 v230, v230, v13
    v_mul_f32 v231, v231, v13
    v_cvt_pk_bf16_f32 v160, v224, v225
    v_cvt_pk_bf16_f32 v161, v226, v227
    v_cvt_pk_bf16_f32 v162, v228, v229
    v_cvt_pk_bf16_f32 v163, v230, v231
    ds_write_b128 v14, v[160:163] offset:4224
    v_dot2_f32_bf16 v224, v164, s56, v12
    v_dot2_f32_bf16 v225, v164, s57, v12
    v_dot2_f32_bf16 v226, v165, s56, v12
    v_dot2_f32_bf16 v227, v165, s57, v12
    v_dot2_f32_bf16 v228, v166, s56, v12
    v_dot2_f32_bf16 v229, v166, s57, v12
    v_dot2_f32_bf16 v230, v167, s56, v12
    v_dot2_f32_bf16 v231, v167, s57, v12
    v_cvt_pk_bf16_f32 v232, v224, v225
    v_cvt_pk_bf16_f32 v233, v226, v227
    v_cvt_pk_bf16_f32 v234, v228, v229
    v_cvt_pk_bf16_f32 v235, v230, v231
    v_lshlrev_b32 v224, 16, v232
    v_and_b32 v225, v236, v232
    v_lshlrev_b32 v226, 16, v233
    v_and_b32 v227, v236, v233
    v_lshlrev_b32 v228, 16, v234
    v_and_b32 v229, v236, v234
    v_lshlrev_b32 v230, 16, v235
    v_and_b32 v231, v236, v235
    v_mul_f32 v224, v224, v13
    v_mul_f32 v225, v225, v13
    v_mul_f32 v226, v226, v13
    v_mul_f32 v227, v227, v13
    v_mul_f32 v228, v228, v13
    v_mul_f32 v229, v229, v13
    v_mul_f32 v230, v230, v13
    v_mul_f32 v231, v231, v13
    v_cvt_pk_bf16_f32 v164, v224, v225
    v_cvt_pk_bf16_f32 v165, v226, v227
    v_cvt_pk_bf16_f32 v166, v228, v229
    v_cvt_pk_bf16_f32 v167, v230, v231
    ds_write_b128 v14, v[164:167] offset:8320
    v_dot2_f32_bf16 v224, v168, s56, v12
    v_dot2_f32_bf16 v225, v168, s57, v12
    v_dot2_f32_bf16 v226, v169, s56, v12
    v_dot2_f32_bf16 v227, v169, s57, v12
    v_dot2_f32_bf16 v228, v170, s56, v12
    v_dot2_f32_bf16 v229, v170, s57, v12
    v_dot2_f32_bf16 v230, v171, s56, v12
    v_dot2_f32_bf16 v231, v171, s57, v12
    v_cvt_pk_bf16_f32 v232, v224, v225
    v_cvt_pk_bf16_f32 v233, v226, v227
    v_cvt_pk_bf16_f32 v234, v228, v229
    v_cvt_pk_bf16_f32 v235, v230, v231
    v_lshlrev_b32 v224, 16, v232
    v_and_b32 v225, v236, v232
    v_lshlrev_b32 v226, 16, v233
    v_and_b32 v227, v236, v233
    v_lshlrev_b32 v228, 16, v234
    v_and_b32 v229, v236, v234
    v_lshlrev_b32 v230, 16, v235
    v_and_b32 v231, v236, v235
    v_mul_f32 v224, v224, v13
    v_mul_f32 v225, v225, v13
    v_mul_f32 v226, v226, v13
    v_mul_f32 v227, v227, v13
    v_mul_f32 v228, v228, v13
    v_mul_f32 v229, v229, v13
    v_mul_f32 v230, v230, v13
    v_mul_f32 v231, v231, v13
    v_cvt_pk_bf16_f32 v168, v224, v225
    v_cvt_pk_bf16_f32 v169, v226, v227
    v_cvt_pk_bf16_f32 v170, v228, v229
    v_cvt_pk_bf16_f32 v171, v230, v231
    ds_write_b128 v14, v[168:171] offset:12416
    v_dot2_f32_bf16 v224, v172, s56, v12
    v_dot2_f32_bf16 v225, v172, s57, v12
    v_dot2_f32_bf16 v226, v173, s56, v12
    v_dot2_f32_bf16 v227, v173, s57, v12
    v_dot2_f32_bf16 v228, v174, s56, v12
    v_dot2_f32_bf16 v229, v174, s57, v12
    v_dot2_f32_bf16 v230, v175, s56, v12
    v_dot2_f32_bf16 v231, v175, s57, v12
    v_cvt_pk_bf16_f32 v232, v224, v225
    v_cvt_pk_bf16_f32 v233, v226, v227
    v_cvt_pk_bf16_f32 v234, v228, v229
    v_cvt_pk_bf16_f32 v235, v230, v231
    v_lshlrev_b32 v224, 16, v232
    v_and_b32 v225, v236, v232
    v_lshlrev_b32 v226, 16, v233
    v_and_b32 v227, v236, v233
    v_lshlrev_b32 v228, 16, v234
    v_and_b32 v229, v236, v234
    v_lshlrev_b32 v230, 16, v235
    v_and_b32 v231, v236, v235
    v_mul_f32 v224, v224, v13
    v_mul_f32 v225, v225, v13
    v_mul_f32 v226, v226, v13
    v_mul_f32 v227, v227, v13
    v_mul_f32 v228, v228, v13
    v_mul_f32 v229, v229, v13
    v_mul_f32 v230, v230, v13
    v_mul_f32 v231, v231, v13
    v_cvt_pk_bf16_f32 v172, v224, v225
    v_cvt_pk_bf16_f32 v173, v226, v227
    v_cvt_pk_bf16_f32 v174, v228, v229
    v_cvt_pk_bf16_f32 v175, v230, v231
    ds_write_b128 v14, v[172:175] offset:16512
    v_dot2_f32_bf16 v224, v176, s56, v12
    v_dot2_f32_bf16 v225, v176, s57, v12
    v_dot2_f32_bf16 v226, v177, s56, v12
    v_dot2_f32_bf16 v227, v177, s57, v12
    v_dot2_f32_bf16 v228, v178, s56, v12
    v_dot2_f32_bf16 v229, v178, s57, v12
    v_dot2_f32_bf16 v230, v179, s56, v12
    v_dot2_f32_bf16 v231, v179, s57, v12
    v_cvt_pk_bf16_f32 v232, v224, v225
    v_cvt_pk_bf16_f32 v233, v226, v227
    v_cvt_pk_bf16_f32 v234, v228, v229
    v_cvt_pk_bf16_f32 v235, v230, v231
    v_lshlrev_b32 v224, 16, v232
    v_and_b32 v225, v236, v232
    v_lshlrev_b32 v226, 16, v233
    v_and_b32 v227, v236, v233
    v_lshlrev_b32 v228, 16, v234
    v_and_b32 v229, v236, v234
    v_lshlrev_b32 v230, 16, v235
    v_and_b32 v231, v236, v235
    v_mul_f32 v224, v224, v13
    v_mul_f32 v225, v225, v13
    v_mul_f32 v226, v226, v13
    v_mul_f32 v227, v227, v13
    v_mul_f32 v228, v228, v13
    v_mul_f32 v229, v229, v13
    v_mul_f32 v230, v230, v13
    v_mul_f32 v231, v231, v13
    v_cvt_pk_bf16_f32 v176, v224, v225
    v_cvt_pk_bf16_f32 v177, v226, v227
    v_cvt_pk_bf16_f32 v178, v228, v229
    v_cvt_pk_bf16_f32 v179, v230, v231
    ds_write_b128 v14, v[176:179] offset:20608
    v_dot2_f32_bf16 v224, v180, s56, v12
    v_dot2_f32_bf16 v225, v180, s57, v12
    v_dot2_f32_bf16 v226, v181, s56, v12
    v_dot2_f32_bf16 v227, v181, s57, v12
    v_dot2_f32_bf16 v228, v182, s56, v12
    v_dot2_f32_bf16 v229, v182, s57, v12
    v_dot2_f32_bf16 v230, v183, s56, v12
    v_dot2_f32_bf16 v231, v183, s57, v12
    v_cvt_pk_bf16_f32 v232, v224, v225
    v_cvt_pk_bf16_f32 v233, v226, v227
    v_cvt_pk_bf16_f32 v234, v228, v229
    v_cvt_pk_bf16_f32 v235, v230, v231
    v_lshlrev_b32 v224, 16, v232
    v_and_b32 v225, v236, v232
    v_lshlrev_b32 v226, 16, v233
    v_and_b32 v227, v236, v233
    v_lshlrev_b32 v228, 16, v234
    v_and_b32 v229, v236, v234
    v_lshlrev_b32 v230, 16, v235
    v_and_b32 v231, v236, v235
    v_mul_f32 v224, v224, v13
    v_mul_f32 v225, v225, v13
    v_mul_f32 v226, v226, v13
    v_mul_f32 v227, v227, v13
    v_mul_f32 v228, v228, v13
    v_mul_f32 v229, v229, v13
    v_mul_f32 v230, v230, v13
    v_mul_f32 v231, v231, v13
    v_cvt_pk_bf16_f32 v180, v224, v225
    v_cvt_pk_bf16_f32 v181, v226, v227
    v_cvt_pk_bf16_f32 v182, v228, v229
    v_cvt_pk_bf16_f32 v183, v230, v231
    ds_write_b128 v14, v[180:183] offset:24704
    s_mul_i32 s49, s47, 28672
    v_xor_b32 v10, 0, v3
    v_xor_b32 v10, v10, v2
    v_lshlrev_b32 v10, 4, v10
    v_lshl_add_u32 v10, v2, 9, v10
    v_add_u32 v10, s49, v10
    v_xor_b32 v11, 2, v3
    v_xor_b32 v11, v11, v2
    v_lshlrev_b32 v11, 4, v11
    v_lshl_add_u32 v11, v2, 9, v11
    v_add_u32 v11, s49, v11
    v_xor_b32 v12, 4, v3
    v_xor_b32 v12, v12, v2
    v_lshlrev_b32 v12, 4, v12
    v_lshl_add_u32 v12, v2, 9, v12
    v_add_u32 v12, s49, v12
    v_xor_b32 v13, 6, v3
    v_xor_b32 v13, v13, v2
    v_lshlrev_b32 v13, 4, v13
    v_lshl_add_u32 v13, v2, 9, v13
    v_add_u32 v13, s49, v13
    s_waitcnt lgkmcnt(0)
    s_barrier
    ds_read_b128 v[16:19], v10 offset:0
    ds_read_b128 v[20:23], v11 offset:1024
    ds_read_b128 v[24:27], v12 offset:2048
    ds_read_b128 v[28:31], v13 offset:3072
    ds_read_b128 v[32:35], v10 offset:4096
    ds_read_b128 v[36:39], v11 offset:5120
    ds_read_b128 v[40:43], v12 offset:6144
    ds_read_b128 v[44:47], v13 offset:7168
    ds_read_b128 v[48:51], v10 offset:8192
    ds_read_b128 v[52:55], v11 offset:9216
    ds_read_b128 v[56:59], v12 offset:10240
    ds_read_b128 v[60:63], v13 offset:11264
    ds_read_b128 v[64:67], v10 offset:12288
    ds_read_b128 v[68:71], v11 offset:13312
    ds_read_b128 v[72:75], v12 offset:14336
    ds_read_b128 v[76:79], v13 offset:15360
    ds_read_b128 v[80:83], v10 offset:16384
    ds_read_b128 v[84:87], v11 offset:17408
    ds_read_b128 v[88:91], v12 offset:18432
    ds_read_b128 v[92:95], v13 offset:19456
    ds_read_b128 v[96:99], v10 offset:20480
    ds_read_b128 v[100:103], v11 offset:21504
    ds_read_b128 v[104:107], v12 offset:22528
    ds_read_b128 v[108:111], v13 offset:23552
    ds_read_b128 v[112:115], v10 offset:24576
    ds_read_b128 v[116:119], v11 offset:25600
    ds_read_b128 v[120:123], v12 offset:26624
    ds_read_b128 v[124:127], v13 offset:27648
    s_waitcnt lgkmcnt(0)
    s_barrier
    s_mov_b64 exec, s[52:53]
    s_add_u32 m0, s59, 0
    s_mov_b32 s50, 516096
    buffer_load_dwordx4 v5, s[28:31], s50 offen lds
    s_add_u32 m0, s59, 768
    s_mov_b32 s50, 526848
    buffer_load_dwordx4 v5, s[28:31], s50 offen lds
    s_mov_b64 exec, -1
    s_mov_b64 exec, s[52:53]
    s_add_u32 m0, s59, 14848
    s_mov_b32 s50, 688128
    buffer_load_dwordx4 v5, s[28:31], s50 offen lds
    s_add_u32 m0, s59, 15616
    s_mov_b32 s50, 698880
    buffer_load_dwordx4 v5, s[28:31], s50 offen lds
    s_mov_b64 exec, -1
    s_mul_i32 s65, s47, 1536
    s_mul_i32 s49, s48, 86016
    v_subrev_u32 v238, s49, v5
    s_cmp_lg_u32 s48, 0
    s_cbranch_scc1 L_s1_ch1
    s_nop 1
    s_waitcnt vmcnt(8)
    s_barrier
    v_add_u32 v9, 114688, v7
    ds_read_b64_tr_b16 v[192:193], v9 offset:0
    ds_read_b64_tr_b16 v[194:195], v9 offset:768
    ds_read_b64_tr_b16 v[196:197], v9 offset:56
    ds_read_b64_tr_b16 v[198:199], v9 offset:824
    s_waitcnt lgkmcnt(2)
    v_mfma_f32_32x32x16_bf16 v[128:143], v[192:195], v[16:19], 0
    ds_read_b64_tr_b16 v[208:209], v9 offset:3072
    ds_read_b64_tr_b16 v[210:211], v9 offset:3840
    s_waitcnt lgkmcnt(2)
    v_mfma_f32_32x32x16_bf16 v[144:159], v[196:199], v[16:19], 0
    ds_read_b64_tr_b16 v[212:213], v9 offset:3128
    ds_read_b64_tr_b16 v[214:215], v9 offset:3896
    s_waitcnt lgkmcnt(2)
    v_mfma_f32_32x32x16_bf16 v[128:143], v[208:211], v[20:23], v[128:143]
    ds_read_b64_tr_b16 v[192:193], v9 offset:6144
    ds_read_b64_tr_b16 v[194:195], v9 offset:6912
    s_waitcnt lgkmcnt(2)
    v_mfma_f32_32x32x16_bf16 v[144:159], v[212:215], v[20:23], v[144:159]
    ds_read_b64_tr_b16 v[196:197], v9 offset:6200
    ds_read_b64_tr_b16 v[198:199], v9 offset:6968
    s_waitcnt lgkmcnt(2)
    v_mfma_f32_32x32x16_bf16 v[128:143], v[192:195], v[24:27], v[128:143]
    ds_read_b64_tr_b16 v[208:209], v9 offset:9216
    ds_read_b64_tr_b16 v[210:211], v9 offset:9984
    s_waitcnt lgkmcnt(2)
    v_mfma_f32_32x32x16_bf16 v[144:159], v[196:199], v[24:27], v[144:159]
    ds_read_b64_tr_b16 v[212:213], v9 offset:9272
    ds_read_b64_tr_b16 v[214:215], v9 offset:10040
    s_waitcnt lgkmcnt(2)
    v_mfma_f32_32x32x16_bf16 v[128:143], v[208:211], v[28:31], v[128:143]
    s_waitcnt vmcnt(6)
    s_barrier
    s_mov_b64 exec, s[52:53]
    s_add_u32 m0, s59, 29696
    s_mov_b32 s50, 860160
    buffer_load_dwordx4 v5, s[28:31], s50 offen lds
    s_add_u32 m0, s59, 30464
    s_mov_b32 s50, 870912
    buffer_load_dwordx4 v5, s[28:31], s50 offen lds
    s_mov_b64 exec, -1
    s_mov_b64 exec, s[52:53]
    s_add_u32 m0, s59, 44544
    s_mov_b32 s50, 1032192
    buffer_load_dwordx4 v5, s[28:31], s50 offen lds
    s_add_u32 m0, s59, 45312
    s_mov_b32 s50, 1042944
    buffer_load_dwordx4 v5, s[28:31], s50 offen lds
    s_mov_b64 exec, -1
    s_mov_b64 exec, s[54:55]
    s_mov_b32 s50, 0
    s_add_u32 m0, s60, 59392
    s_nop 0
    buffer_load_dwordx4 v6, s[32:35], s50 offen lds
    s_add_u32 m0, s60, 66688
    s_nop 0
    buffer_load_dwordx4 v6, s[36:39], s50 offen lds
    s_mov_b64 exec, -1
    v_add_u32 v9, 129536, v7
    ds_read_b64_tr_b16 v[192:193], v9 offset:0
    ds_read_b64_tr_b16 v[194:195], v9 offset:768
    s_waitcnt lgkmcnt(2)
    v_mfma_f32_32x32x16_bf16 v[144:159], v[212:215], v[28:31], v[144:159]
    ds_read_b64_tr_b16 v[196:197], v9 offset:56
    ds_read_b64_tr_b16 v[198:199], v9 offset:824
    s_waitcnt lgkmcnt(2)
    v_mfma_f32_32x32x16_bf16 v[128:143], v[192:195], v[32:35], v[128:143]
    ds_read_b64_tr_b16 v[208:209], v9 offset:3072
    ds_read_b64_tr_b16 v[210:211], v9 offset:3840
    s_waitcnt lgkmcnt(2)
    v_mfma_f32_32x32x16_bf16 v[144:159], v[196:199], v[32:35], v[144:159]
    ds_read_b64_tr_b16 v[212:213], v9 offset:3128
    ds_read_b64_tr_b16 v[214:215], v9 offset:3896
    s_waitcnt lgkmcnt(2)
    v_mfma_f32_32x32x16_bf16 v[128:143], v[208:211], v[36:39], v[128:143]
    ds_read_b64_tr_b16 v[192:193], v9 offset:6144
    ds_read_b64_tr_b16 v[194:195], v9 offset:6912
    s_waitcnt lgkmcnt(2)
    v_mfma_f32_32x32x16_bf16 v[144:159], v[212:215], v[36:39], v[144:159]
    ds_read_b64_tr_b16 v[196:197], v9 offset:6200
    ds_read_b64_tr_b16 v[198:199], v9 offset:6968
    s_waitcnt lgkmcnt(2)
    v_mfma_f32_32x32x16_bf16 v[128:143], v[192:195], v[40:43], v[128:143]
    ds_read_b64_tr_b16 v[208:209], v9 offset:9216
    ds_read_b64_tr_b16 v[210:211], v9 offset:9984
    s_waitcnt lgkmcnt(2)
    v_mfma_f32_32x32x16_bf16 v[144:159], v[196:199], v[40:43], v[144:159]
    ds_read_b64_tr_b16 v[212:213], v9 offset:9272
    ds_read_b64_tr_b16 v[214:215], v9 offset:10040
    s_waitcnt lgkmcnt(2)
    v_mfma_f32_32x32x16_bf16 v[128:143], v[208:211], v[44:47], v[128:143]
    s_waitcnt vmcnt(10)
    s_barrier
    s_mov_b64 exec, s[54:55]
    s_mov_b32 s50, 114688
    s_add_u32 m0, s60, 74240
    s_nop 0
    buffer_load_dwordx4 v6, s[32:35], s50 offen lds
    s_add_u32 m0, s60, 81536
    s_nop 0
    buffer_load_dwordx4 v6, s[36:39], s50 offen lds
    s_mov_b64 exec, -1
    s_mov_b64 exec, s[54:55]
    s_mov_b32 s50, 229376
    s_add_u32 m0, s60, 89088
    s_nop 0
    buffer_load_dwordx4 v6, s[32:35], s50 offen lds
    s_add_u32 m0, s60, 96384
    s_nop 0
    buffer_load_dwordx4 v6, s[36:39], s50 offen lds
    s_mov_b64 exec, -1
    s_mov_b64 exec, s[54:55]
    s_mov_b32 s50, 344064
    s_add_u32 m0, s60, 114688
    s_nop 0
    buffer_load_dwordx4 v6, s[32:35], s50 offen lds
    s_add_u32 m0, s60, 121984
    s_nop 0
    buffer_load_dwordx4 v6, s[36:39], s50 offen lds
    s_mov_b64 exec, -1
    v_add_u32 v9, 144384, v7
    ds_read_b64_tr_b16 v[192:193], v9 offset:0
    ds_read_b64_tr_b16 v[194:195], v9 offset:768
    s_waitcnt lgkmcnt(2)
    v_mfma_f32_32x32x16_bf16 v[144:159], v[212:215], v[44:47], v[144:159]
    ds_read_b64_tr_b16 v[196:197], v9 offset:56
    ds_read_b64_tr_b16 v[198:199], v9 offset:824
    s_waitcnt lgkmcnt(2)
    v_mfma_f32_32x32x16_bf16 v[128:143], v[192:195], v[48:51], v[128:143]
    ds_read_b64_tr_b16 v[208:209], v9 offset:3072
    ds_read_b64_tr_b16 v[210:211], v9 offset:3840
    s_waitcnt lgkmcnt(2)
    v_mfma_f32_32x32x16_bf16 v[144:159], v[196:199], v[48:51], v[144:159]
    ds_read_b64_tr_b16 v[212:213], v9 offset:3128
    ds_read_b64_tr_b16 v[214:215], v9 offset:3896
    s_waitcnt lgkmcnt(2)
    v_mfma_f32_32x32x16_bf16 v[128:143], v[208:211], v[52:55], v[128:143]
    ds_read_b64_tr_b16 v[192:193], v9 offset:6144
    ds_read_b64_tr_b16 v[194:195], v9 offset:6912
    s_waitcnt lgkmcnt(2)
    v_mfma_f32_32x32x16_bf16 v[144:159], v[212:215], v[52:55], v[144:159]
    ds_read_b64_tr_b16 v[196:197], v9 offset:6200
    ds_read_b64_tr_b16 v[198:199], v9 offset:6968
    s_waitcnt lgkmcnt(2)
    v_mfma_f32_32x32x16_bf16 v[128:143], v[192:195], v[56:59], v[128:143]
    ds_read_b64_tr_b16 v[208:209], v9 offset:9216
    ds_read_b64_tr_b16 v[210:211], v9 offset:9984
    s_waitcnt lgkmcnt(2)
    v_mfma_f32_32x32x16_bf16 v[144:159], v[196:199], v[56:59], v[144:159]
    ds_read_b64_tr_b16 v[212:213], v9 offset:9272
    ds_read_b64_tr_b16 v[214:215], v9 offset:10040
    s_waitcnt lgkmcnt(2)
    v_mfma_f32_32x32x16_bf16 v[128:143], v[208:211], v[60:63], v[128:143]
    s_waitcnt vmcnt(14)
    s_barrier
    s_mov_b64 exec, s[54:55]
    s_mov_b32 s50, 458752
    s_add_u32 m0, s60, 129536
    s_nop 0
    buffer_load_dwordx4 v6, s[32:35], s50 offen lds
    s_add_u32 m0, s60, 136832
    s_nop 0
    buffer_load_dwordx4 v6, s[36:39], s50 offen lds
    s_mov_b64 exec, -1
    v_add_u32 v9, 0, v7
    ds_read_b64_tr_b16 v[192:193], v9 offset:0
    ds_read_b64_tr_b16 v[194:195], v9 offset:768
    s_waitcnt lgkmcnt(2)
    v_mfma_f32_32x32x16_bf16 v[144:159], v[212:215], v[60:63], v[144:159]
    ds_read_b64_tr_b16 v[196:197], v9 offset:56
    ds_read_b64_tr_b16 v[198:199], v9 offset:824
    s_waitcnt lgkmcnt(2)
    v_mfma_f32_32x32x16_bf16 v[128:143], v[192:195], v[64:67], v[128:143]
    ds_read_b64_tr_b16 v[208:209], v9 offset:3072
    ds_read_b64_tr_b16 v[210:211], v9 offset:3840
    s_waitcnt lgkmcnt(2)
    v_mfma_f32_32x32x16_bf16 v[144:159], v[196:199], v[64:67], v[144:159]
    ds_read_b64_tr_b16 v[212:213], v9 offset:3128
    ds_read_b64_tr_b16 v[214:215], v9 offset:3896
    s_waitcnt lgkmcnt(2)
    v_mfma_f32_32x32x16_bf16 v[128:143], v[208:211], v[68:71], v[128:143]
    ds_read_b64_tr_b16 v[192:193], v9 offset:6144
    ds_read_b64_tr_b16 v[194:195], v9 offset:6912
    s_waitcnt lgkmcnt(2)
    v_mfma_f32_32x32x16_bf16 v[144:159], v[212:215], v[68:71], v[144:159]
    ds_read_b64_tr_b16 v[196:197], v9 offset:6200
    ds_read_b64_tr_b16 v[198:199], v9 offset:6968
    s_waitcnt lgkmcnt(2)
    v_mfma_f32_32x32x16_bf16 v[128:143], v[192:195], v[72:75], v[128:143]
    ds_read_b64_tr_b16 v[208:209], v9 offset:9216
    ds_read_b64_tr_b16 v[210:211], v9 offset:9984
    s_waitcnt lgkmcnt(2)
    v_mfma_f32_32x32x16_bf16 v[144:159], v[196:199], v[72:75], v[144:159]
    ds_read_b64_tr_b16 v[212:213], v9 offset:9272
    ds_read_b64_tr_b16 v[214:215], v9 offset:10040
    s_waitcnt lgkmcnt(2)
    v_mfma_f32_32x32x16_bf16 v[128:143], v[208:211], v[76:79], v[128:143]
    s_waitcnt vmcnt(14)
    s_barrier
    s_mov_b64 exec, s[54:55]
    s_mov_b32 s50, 573440
    s_add_u32 m0, s60, 144384
    s_nop 0
    buffer_load_dwordx4 v6, s[32:35], s50 offen lds
    s_add_u32 m0, s60, 151680
    s_nop 0
    buffer_load_dwordx4 v6, s[36:39], s50 offen lds
    s_mov_b64 exec, -1
    v_add_u32 v9, 14848, v7
    ds_read_b64_tr_b16 v[192:193], v9 offset:0
    ds_read_b64_tr_b16 v[194:195], v9 offset:768
    s_waitcnt lgkmcnt(2)
    v_mfma_f32_32x32x16_bf16 v[144:159], v[212:215], v[76:79], v[144:159]
    ds_read_b64_tr_b16 v[196:197], v9 offset:56
    ds_read_b64_tr_b16 v[198:199], v9 offset:824
    s_waitcnt lgkmcnt(2)
    v_mfma_f32_32x32x16_bf16 v[128:143], v[192:195], v[80:83], v[128:143]
    ds_read_b64_tr_b16 v[208:209], v9 offset:3072
    ds_read_b64_tr_b16 v[210:211], v9 offset:3840
    s_waitcnt lgkmcnt(2)
    v_mfma_f32_32x32x16_bf16 v[144:159], v[196:199], v[80:83], v[144:159]
    ds_read_b64_tr_b16 v[212:213], v9 offset:3128
    ds_read_b64_tr_b16 v[214:215], v9 offset:3896
    s_waitcnt lgkmcnt(2)
    v_mfma_f32_32x32x16_bf16 v[128:143], v[208:211], v[84:87], v[128:143]
    ds_read_b64_tr_b16 v[192:193], v9 offset:6144
    ds_read_b64_tr_b16 v[194:195], v9 offset:6912
    s_waitcnt lgkmcnt(2)
    v_mfma_f32_32x32x16_bf16 v[144:159], v[212:215], v[84:87], v[144:159]
    ds_read_b64_tr_b16 v[196:197], v9 offset:6200
    ds_read_b64_tr_b16 v[198:199], v9 offset:6968
    s_waitcnt lgkmcnt(2)
    v_mfma_f32_32x32x16_bf16 v[128:143], v[192:195], v[88:91], v[128:143]
    ds_read_b64_tr_b16 v[208:209], v9 offset:9216
    ds_read_b64_tr_b16 v[210:211], v9 offset:9984
    s_waitcnt lgkmcnt(2)
    v_mfma_f32_32x32x16_bf16 v[144:159], v[196:199], v[88:91], v[144:159]
    ds_read_b64_tr_b16 v[212:213], v9 offset:9272
    ds_read_b64_tr_b16 v[214:215], v9 offset:10040
    s_waitcnt lgkmcnt(2)
    v_mfma_f32_32x32x16_bf16 v[128:143], v[208:211], v[92:95], v[128:143]
    s_waitcnt vmcnt(14)
    s_barrier
    s_mov_b64 exec, s[54:55]
    s_mov_b32 s50, 688128
    s_add_u32 m0, s60, 0
    s_nop 0
    buffer_load_dwordx4 v6, s[32:35], s50 offen lds
    s_add_u32 m0, s60, 7296
    s_nop 0
    buffer_load_dwordx4 v6, s[36:39], s50 offen lds
    s_mov_b64 exec, -1
    v_add_u32 v9, 29696, v7
    ds_read_b64_tr_b16 v[192:193], v9 offset:0
    ds_read_b64_tr_b16 v[194:195], v9 offset:768
    s_waitcnt lgkmcnt(2)
    v_mfma_f32_32x32x16_bf16 v[144:159], v[212:215], v[92:95], v[144:159]
    ds_read_b64_tr_b16 v[196:197], v9 offset:56
    ds_read_b64_tr_b16 v[198:199], v9 offset:824
    s_waitcnt lgkmcnt(2)
    v_mfma_f32_32x32x16_bf16 v[128:143], v[192:195], v[96:99], v[128:143]
    ds_read_b64_tr_b16 v[208:209], v9 offset:3072
    ds_read_b64_tr_b16 v[210:211], v9 offset:3840
    s_waitcnt lgkmcnt(2)
    v_mfma_f32_32x32x16_bf16 v[144:159], v[196:199], v[96:99], v[144:159]
    ds_read_b64_tr_b16 v[212:213], v9 offset:3128
    ds_read_b64_tr_b16 v[214:215], v9 offset:3896
    s_waitcnt lgkmcnt(2)
    v_mfma_f32_32x32x16_bf16 v[128:143], v[208:211], v[100:103], v[128:143]
    ds_read_b64_tr_b16 v[192:193], v9 offset:6144
    ds_read_b64_tr_b16 v[194:195], v9 offset:6912
    s_waitcnt lgkmcnt(2)
    v_mfma_f32_32x32x16_bf16 v[144:159], v[212:215], v[100:103], v[144:159]
    ds_read_b64_tr_b16 v[196:197], v9 offset:6200
    ds_read_b64_tr_b16 v[198:199], v9 offset:6968
    s_waitcnt lgkmcnt(2)
    v_mfma_f32_32x32x16_bf16 v[128:143], v[192:195], v[104:107], v[128:143]
    ds_read_b64_tr_b16 v[208:209], v9 offset:9216
    ds_read_b64_tr_b16 v[210:211], v9 offset:9984
    s_waitcnt lgkmcnt(2)
    v_mfma_f32_32x32x16_bf16 v[144:159], v[196:199], v[104:107], v[144:159]
    ds_read_b64_tr_b16 v[212:213], v9 offset:9272
    ds_read_b64_tr_b16 v[214:215], v9 offset:10040
    s_waitcnt lgkmcnt(2)
    v_mfma_f32_32x32x16_bf16 v[128:143], v[208:211], v[108:111], v[128:143]
    s_waitcnt vmcnt(14)
    s_barrier
    s_mov_b64 exec, s[54:55]
    s_mov_b32 s50, 802816
    s_add_u32 m0, s60, 14848
    s_nop 0
    buffer_load_dwordx4 v6, s[32:35], s50 offen lds
    s_add_u32 m0, s60, 22144
    s_nop 0
    buffer_load_dwordx4 v6, s[36:39], s50 offen lds
    s_mov_b64 exec, -1
    v_add_u32 v9, 44544, v7
    ds_read_b64_tr_b16 v[192:193], v9 offset:0
    ds_read_b64_tr_b16 v[194:195], v9 offset:768
    s_waitcnt lgkmcnt(2)
    v_mfma_f32_32x32x16_bf16 v[144:159], v[212:215], v[108:111], v[144:159]
    ds_read_b64_tr_b16 v[196:197], v9 offset:56
    ds_read_b64_tr_b16 v[198:199], v9 offset:824
    s_waitcnt lgkmcnt(2)
    v_mfma_f32_32x32x16_bf16 v[128:143], v[192:195], v[112:115], v[128:143]
    ds_read_b64_tr_b16 v[208:209], v9 offset:3072
    ds_read_b64_tr_b16 v[210:211], v9 offset:3840
    s_waitcnt lgkmcnt(2)
    v_mfma_f32_32x32x16_bf16 v[144:159], v[196:199], v[112:115], v[144:159]
    ds_read_b64_tr_b16 v[212:213], v9 offset:3128
    ds_read_b64_tr_b16 v[214:215], v9 offset:3896
    s_waitcnt lgkmcnt(2)
    v_mfma_f32_32x32x16_bf16 v[128:143], v[208:211], v[116:119], v[128:143]
    ds_read_b64_tr_b16 v[192:193], v9 offset:6144
    ds_read_b64_tr_b16 v[194:195], v9 offset:6912
    s_waitcnt lgkmcnt(2)
    v_mfma_f32_32x32x16_bf16 v[144:159], v[212:215], v[116:119], v[144:159]
    ds_read_b64_tr_b16 v[196:197], v9 offset:6200
    ds_read_b64_tr_b16 v[198:199], v9 offset:6968
    s_waitcnt lgkmcnt(2)
    v_mfma_f32_32x32x16_bf16 v[128:143], v[192:195], v[120:123], v[128:143]
    ds_read_b64_tr_b16 v[208:209], v9 offset:9216
    ds_read_b64_tr_b16 v[210:211], v9 offset:9984
    s_waitcnt lgkmcnt(2)
    v_mfma_f32_32x32x16_bf16 v[144:159], v[196:199], v[120:123], v[144:159]
    ds_read_b64_tr_b16 v[212:213], v9 offset:9272
    ds_read_b64_tr_b16 v[214:215], v9 offset:10040
    s_waitcnt lgkmcnt(2)
    v_mfma_f32_32x32x16_bf16 v[128:143], v[208:211], v[124:127], v[128:143]
    s_cmp_lg_u32 s46, 0
    s_cbranch_scc1 L_nonf_3
    v_readfirstlane_b32 s92, v248
    v_readfirstlane_b32 s93, v249
    s_nop 3
    s_cmp_eq_u64 s[92:93], 0
    s_cselect_b32 s90, s90, s92
    s_cselect_b32 s91, s91, s93
    v_mov_b32 v248, s90
    v_mov_b32 v249, s91
    v_mov_b32 v252, 159232
    ds_write_b64 v252, v[248:249]
    v_mov_b32 v248, 0
    v_mov_b32 v249, 0
    ds_write_b64 v252, v[248:249] offset:8
    s_waitcnt lgkmcnt(0)
L_nonf_3:
    s_waitcnt vmcnt(12)
    s_barrier
    s_mov_b64 exec, s[54:55]
    s_mov_b32 s50, 917504
    s_add_u32 m0, s60, 29696
    s_nop 0
    buffer_load_dwordx4 v6, s[32:35], s50 offen lds
    s_add_u32 m0, s60, 36992
    s_nop 0
    buffer_load_dwordx4 v6, s[36:39], s50 offen lds
    s_mov_b64 exec, -1
    v_add_u32 v9, 59392, v8
    ds_read_b64_tr_b16 v[192:193], v9 offset:0
    ds_read_b64_tr_b16 v[194:195], v9 offset:896
    s_waitcnt lgkmcnt(2)
    v_mfma_f32_32x32x16_bf16 v[144:159], v[212:215], v[124:127], v[144:159]
    ds_read_b64_tr_b16 v[196:197], v9 offset:32
    ds_read_b64_tr_b16 v[198:199], v9 offset:928
    ds_read_b64_tr_b16 v[200:201], v9 offset:64
    ds_read_b64_tr_b16 v[202:203], v9 offset:960
    s_mul_i32 s49, s44, 3
    s_add_u32 s49, s49, 0
    s_lshl_b32 s50, s49, 17
    s_cmp_ge_u32 s49, 32
    s_cselect_b32 s51, 0x3f803f80, 0
    v_mov_b32 v12, s51
    v_cvt_pk_bf16_f32 v224, v128, v129
    v_cvt_pk_bf16_f32 v225, v130, v131
    v_cvt_pk_bf16_f32 v226, v132, v133
    v_cvt_pk_bf16_f32 v227, v134, v135
    v_cvt_pk_bf16_f32 v228, v136, v137
    v_cvt_pk_bf16_f32 v229, v138, v139
    v_cvt_pk_bf16_f32 v230, v140, v141
    v_cvt_pk_bf16_f32 v231, v142, v143
    v_cndmask_b32 v230, v230, v12, s[62:63]
    v_cndmask_b32 v231, v231, v12, s[62:63]
    buffer_store_dwordx4 v[224:227], v240, s[40:43], s50 offen sc1
    buffer_store_dwordx4 v[228:231], v240, s[40:43], s50 offen offset:256 sc1
    s_mul_i32 s49, s44, 3
    s_add_u32 s49, s49, 1
    s_lshl_b32 s50, s49, 17
    s_cmp_ge_u32 s49, 32
    s_cselect_b32 s51, 0x3f803f80, 0
    v_mov_b32 v12, s51
    v_cvt_pk_bf16_f32 v232, v144, v145
    v_cvt_pk_bf16_f32 v233, v146, v147
    v_cvt_pk_bf16_f32 v234, v148, v149
    v_cvt_pk_bf16_f32 v235, v150, v151
    v_cvt_pk_bf16_f32 v236, v152, v153
    v_cvt_pk_bf16_f32 v237, v154, v155
    v_cvt_pk_bf16_f32 v238, v156, v157
    v_cvt_pk_bf16_f32 v239, v158, v159
    v_cndmask_b32 v238, v238, v12, s[62:63]
    v_cndmask_b32 v239, v239, v12, s[62:63]
    buffer_store_dwordx4 v[232:235], v240, s[40:43], s50 offen sc1
    buffer_store_dwordx4 v[236:239], v240, s[40:43], s50 offen offset:256 sc1
    s_waitcnt lgkmcnt(4)
    v_mfma_f32_32x32x16_bf16 v[128:143], v[192:195], v[16:19], 0
    ds_read_b64_tr_b16 v[208:209], v9 offset:3584
    ds_read_b64_tr_b16 v[210:211], v9 offset:4480
    s_waitcnt lgkmcnt(4)
    v_mfma_f32_32x32x16_bf16 v[144:159], v[196:199], v[16:19], 0
    ds_read_b64_tr_b16 v[212:213], v9 offset:3616
    ds_read_b64_tr_b16 v[214:215], v9 offset:4512
    s_waitcnt lgkmcnt(4)
    v_mfma_f32_32x32x16_bf16 v[160:175], v[200:203], v[16:19], 0
    ds_read_b64_tr_b16 v[216:217], v9 offset:3648
    ds_read_b64_tr_b16 v[218:219], v9 offset:4544
    s_waitcnt lgkmcnt(4)
    v_mfma_f32_32x32x16_bf16 v[128:143], v[208:211], v[20:23], v[128:143]
    v_add_u32 v9, 74240, v8
    ds_read_b64_tr_b16 v[192:193], v9 offset:0
    ds_read_b64_tr_b16 v[194:195], v9 offset:896
    s_waitcnt lgkmcnt(4)
    v_mfma_f32_32x32x16_bf16 v[144:159], v[212:215], v[20:23], v[144:159]
    ds_read_b64_tr_b16 v[196:197], v9 offset:32
    ds_read_b64_tr_b16 v[198:199], v9 offset:928
    s_waitcnt lgkmcnt(4)
    v_mfma_f32_32x32x16_bf16 v[160:175], v[216:219], v[20:23], v[160:175]
    ds_read_b64_tr_b16 v[200:201], v9 offset:64
    ds_read_b64_tr_b16 v[202:203], v9 offset:960
    s_waitcnt lgkmcnt(4)
    v_mfma_f32_32x32x16_bf16 v[128:143], v[192:195], v[24:27], v[128:143]
    ds_read_b64_tr_b16 v[208:209], v9 offset:3584
    ds_read_b64_tr_b16 v[210:211], v9 offset:4480
    s_waitcnt lgkmcnt(4)
    v_mfma_f32_32x32x16_bf16 v[144:159], v[196:199], v[24:27], v[144:159]
    ds_read_b64_tr_b16 v[212:213], v9 offset:3616
    ds_read_b64_tr_b16 v[214:215], v9 offset:4512
    s_waitcnt lgkmcnt(4)
    v_mfma_f32_32x32x16_bf16 v[160:175], v[200:203], v[24:27], v[160:175]
    ds_read_b64_tr_b16 v[216:217], v9 offset:3648
    ds_read_b64_tr_b16 v[218:219], v9 offset:4544
    s_waitcnt lgkmcnt(4)
    v_mfma_f32_32x32x16_bf16 v[128:143], v[208:211], v[28:31], v[128:143]
    s_waitcnt vmcnt(0)
    s_waitcnt vmcnt(14)
    s_barrier
    s_cmp_lg_u32 s46, 0
    s_cbranch_scc1 L_pub_4
    s_lshl_b32 s92, s94, 3
    s_add_u32 s92, s92, 25165824
    v_mov_b32 v248, s90
    v_mov_b32 v249, s91
    v_mov_b32 v255, s92
    s_mov_b64 exec, 1
    buffer_store_dwordx2 v[248:249], v255, s[96:99], 0 offen sc1
    s_mov_b64 exec, -1
L_pub_4:
    s_mov_b64 exec, s[54:55]
    s_mov_b32 s50, 1032192
    s_add_u32 m0, s60, 44544
    s_nop 0
    buffer_load_dwordx4 v6, s[32:35], s50 offen lds
    s_add_u32 m0, s60, 51840
    s_nop 0
    buffer_load_dwordx4 v6, s[36:39], s50 offen lds
    s_mov_b64 exec, -1
    s_mov_b64 exec, s[54:55]
    s_mov_b32 s50, 1146880
    s_add_u32 m0, s60, 59392
    s_nop 0
    buffer_load_dwordx4 v6, s[32:35], s50 offen lds
    s_add_u32 m0, s60, 66688
    s_nop 0
    buffer_load_dwordx4 v6, s[36:39], s50 offen lds
    s_mov_b64 exec, -1
    v_add_u32 v9, 89088, v8
    ds_read_b64_tr_b16 v[192:193], v9 offset:0
    ds_read_b64_tr_b16 v[194:195], v9 offset:896
    s_waitcnt lgkmcnt(4)
    v_mfma_f32_32x32x16_bf16 v[144:159], v[212:215], v[28:31], v[144:159]
    ds_read_b64_tr_b16 v[196:197], v9 offset:32
    ds_read_b64_tr_b16 v[198:199], v9 offset:928
    s_waitcnt lgkmcnt(4)
    v_mfma_f32_32x32x16_bf16 v[160:175], v[216:219], v[28:31], v[160:175]
    ds_read_b64_tr_b16 v[200:201], v9 offset:64
    ds_read_b64_tr_b16 v[202:203], v9 offset:960
    s_waitcnt lgkmcnt(4)
    v_mfma_f32_32x32x16_bf16 v[128:143], v[192:195], v[32:35], v[128:143]
    ds_read_b64_tr_b16 v[208:209], v9 offset:3584
    ds_read_b64_tr_b16 v[210:211], v9 offset:4480
    s_waitcnt lgkmcnt(4)
    v_mfma_f32_32x32x16_bf16 v[144:159], v[196:199], v[32:35], v[144:159]
    ds_read_b64_tr_b16 v[212:213], v9 offset:3616
    ds_read_b64_tr_b16 v[214:215], v9 offset:4512
    s_waitcnt lgkmcnt(4)
    v_mfma_f32_32x32x16_bf16 v[160:175], v[200:203], v[32:35], v[160:175]
    ds_read_b64_tr_b16 v[216:217], v9 offset:3648
    ds_read_b64_tr_b16 v[218:219], v9 offset:4544
    s_waitcnt lgkmcnt(4)
    v_mfma_f32_32x32x16_bf16 v[128:143], v[208:211], v[36:39], v[128:143]
    v_add_u32 v9, 114688, v8
    ds_read_b64_tr_b16 v[192:193], v9 offset:0
    ds_read_b64_tr_b16 v[194:195], v9 offset:896
    s_waitcnt lgkmcnt(4)
    v_mfma_f32_32x32x16_bf16 v[144:159], v[212:215], v[36:39], v[144:159]
    ds_read_b64_tr_b16 v[196:197], v9 offset:32
    ds_read_b64_tr_b16 v[198:199], v9 offset:928
    s_waitcnt lgkmcnt(4)
    v_mfma_f32_32x32x16_bf16 v[160:175], v[216:219], v[36:39], v[160:175]
    ds_read_b64_tr_b16 v[200:201], v9 offset:64
    ds_read_b64_tr_b16 v[202:203], v9 offset:960
    s_waitcnt lgkmcnt(4)
    v_mfma_f32_32x32x16_bf16 v[128:143], v[192:195], v[40:43], v[128:143]
    ds_read_b64_tr_b16 v[208:209], v9 offset:3584
    ds_read_b64_tr_b16 v[210:211], v9 offset:4480
    s_waitcnt lgkmcnt(4)
    v_mfma_f32_32x32x16_bf16 v[144:159], v[196:199], v[40:43], v[144:159]
    ds_read_b64_tr_b16 v[212:213], v9 offset:3616
    ds_read_b64_tr_b16 v[214:215], v9 offset:4512
    s_waitcnt lgkmcnt(4)
    v_mfma_f32_32x32x16_bf16 v[160:175], v[200:203], v[40:43], v[160:175]
    ds_read_b64_tr_b16 v[216:217], v9 offset:3648
    ds_read_b64_tr_b16 v[218:219], v9 offset:4544
    s_waitcnt lgkmcnt(4)
    v_mfma_f32_32x32x16_bf16 v[128:143], v[208:211], v[44:47], v[128:143]
    s_waitcnt vmcnt(14)
    s_barrier
    s_mov_b64 exec, s[54:55]
    s_mov_b32 s50, 1261568
    s_add_u32 m0, s60, 74240
    s_nop 0
    buffer_load_dwordx4 v6, s[32:35], s50 offen lds
    s_add_u32 m0, s60, 81536
    s_nop 0
    buffer_load_dwordx4 v6, s[36:39], s50 offen lds
    s_mov_b64 exec, -1
    s_mov_b64 exec, s[54:55]
    s_mov_b32 s50, 1376256
    s_add_u32 m0, s60, 89088
    s_nop 0
    buffer_load_dwordx4 v6, s[32:35], s50 offen lds
    s_add_u32 m0, s60, 96384
    s_nop 0
    buffer_load_dwordx4 v6, s[36:39], s50 offen lds
    s_mov_b64 exec, -1
    v_add_u32 v9, 129536, v8
    ds_read_b64_tr_b16 v[192:193], v9 offset:0
    ds_read_b64_tr_b16 v[194:195], v9 offset:896
    s_waitcnt lgkmcnt(4)
    v_mfma_f32_32x32x16_bf16 v[144:159], v[212:215], v[44:47], v[144:159]
    ds_read_b64_tr_b16 v[196:197], v9 offset:32
    ds_read_b64_tr_b16 v[198:199], v9 offset:928
    s_waitcnt lgkmcnt(4)
    v_mfma_f32_32x32x16_bf16 v[160:175], v[216:219], v[44:47], v[160:175]
    ds_read_b64_tr_b16 v[200:201], v9 offset:64
    ds_read_b64_tr_b16 v[202:203], v9 offset:960
    s_waitcnt lgkmcnt(4)
    v_mfma_f32_32x32x16_bf16 v[128:143], v[192:195], v[48:51], v[128:143]
    ds_read_b64_tr_b16 v[208:209], v9 offset:3584
    ds_read_b64_tr_b16 v[210:211], v9 offset:4480
    s_waitcnt lgkmcnt(4)
    v_mfma_f32_32x32x16_bf16 v[144:159], v[196:199], v[48:51], v[144:159]
    ds_read_b64_tr_b16 v[212:213], v9 offset:3616
    ds_read_b64_tr_b16 v[214:215], v9 offset:4512
    s_waitcnt lgkmcnt(4)
    v_mfma_f32_32x32x16_bf16 v[160:175], v[200:203], v[48:51], v[160:175]
    ds_read_b64_tr_b16 v[216:217], v9 offset:3648
    ds_read_b64_tr_b16 v[218:219], v9 offset:4544
    s_waitcnt lgkmcnt(4)
    v_mfma_f32_32x32x16_bf16 v[128:143], v[208:211], v[52:55], v[128:143]
    v_add_u32 v9, 144384, v8
    ds_read_b64_tr_b16 v[192:193], v9 offset:0
    ds_read_b64_tr_b16 v[194:195], v9 offset:896
    s_waitcnt lgkmcnt(4)
    v_mfma_f32_32x32x16_bf16 v[144:159], v[212:215], v[52:55], v[144:159]
    ds_read_b64_tr_b16 v[196:197], v9 offset:32
    ds_read_b64_tr_b16 v[198:199], v9 offset:928
    s_waitcnt lgkmcnt(4)
    v_mfma_f32_32x32x16_bf16 v[160:175], v[216:219], v[52:55], v[160:175]
    ds_read_b64_tr_b16 v[200:201], v9 offset:64
    ds_read_b64_tr_b16 v[202:203], v9 offset:960
    s_waitcnt lgkmcnt(4)
    v_mfma_f32_32x32x16_bf16 v[128:143], v[192:195], v[56:59], v[128:143]
    ds_read_b64_tr_b16 v[208:209], v9 offset:3584
    ds_read_b64_tr_b16 v[210:211], v9 offset:4480
    s_waitcnt lgkmcnt(4)
    v_mfma_f32_32x32x16_bf16 v[144:159], v[196:199], v[56:59], v[144:159]
    ds_read_b64_tr_b16 v[212:213], v9 offset:3616
    ds_read_b64_tr_b16 v[214:215], v9 offset:4512
    s_waitcnt lgkmcnt(4)
    v_mfma_f32_32x32x16_bf16 v[160:175], v[200:203], v[56:59], v[160:175]
    ds_read_b64_tr_b16 v[216:217], v9 offset:3648
    ds_read_b64_tr_b16 v[218:219], v9 offset:4544
    s_waitcnt lgkmcnt(4)
    v_mfma_f32_32x32x16_bf16 v[128:143], v[208:211], v[60:63], v[128:143]
    s_waitcnt vmcnt(14)
    s_barrier
    s_mov_b64 exec, s[54:55]
    s_mov_b32 s50, 1490944
    s_add_u32 m0, s60, 114688
    s_nop 0
    buffer_load_dwordx4 v6, s[32:35], s50 offen lds
    s_add_u32 m0, s60, 121984
    s_nop 0
    buffer_load_dwordx4 v6, s[36:39], s50 offen lds
    s_mov_b64 exec, -1
    s_cmp_lg_u32 s46, 0
    s_cbranch_scc1 L_kvp_5
    v_add_u32 v12, 1, v1
    v_lshrrev_b32 v13, 1, v12
    v_subrev_u32 v13, 1, v13
    v_max_i32 v13, 0, v13
    v_and_b32 v14, 1, v1
    v_sub_u32 v14, 2, v14
    v_cmp_eq_u32 vcc, 0, v1
    s_nop 1
    v_cndmask_b32 v14, v14, 0, vcc
    v_lshlrev_b32 v14, 4, v14
    v_add_u32 v14, s44, v14
    v_mul_u32_u24 v14, 43, v14
    v_lshrrev_b32 v14, 7, v14
    v_sub_u32 v13, s45, v13
    v_max_i32 v13, 0, v13
    v_lshl_add_u32 v13, v13, 4, v14
    v_lshlrev_b32 v255, 3, v13
    v_add_u32 v255, 25165824, v255
    s_mov_b64 exec, 0x7f
    buffer_load_dwordx2 v[252:253], v255, s[96:99], 0 offen sc1
    s_mov_b64 exec, -1
L_kvp_5:
    v_add_u32 v9, 0, v8
    ds_read_b64_tr_b16 v[192:193], v9 offset:0
    ds_read_b64_tr_b16 v[194:195], v9 offset:896
    s_waitcnt lgkmcnt(4)
    v_mfma_f32_32x32x16_bf16 v[144:159], v[212:215], v[60:63], v[144:159]
    ds_read_b64_tr_b16 v[196:197], v9 offset:32
    ds_read_b64_tr_b16 v[198:199], v9 offset:928
    s_waitcnt lgkmcnt(4)
    v_mfma_f32_32x32x16_bf16 v[160:175], v[216:219], v[60:63], v[160:175]
    ds_read_b64_tr_b16 v[200:201], v9 offset:64
    ds_read_b64_tr_b16 v[202:203], v9 offset:960
    s_waitcnt lgkmcnt(4)
    v_mfma_f32_32x32x16_bf16 v[128:143], v[192:195], v[64:67], v[128:143]
    ds_read_b64_tr_b16 v[208:209], v9 offset:3584
    ds_read_b64_tr_b16 v[210:211], v9 offset:4480
    s_waitcnt lgkmcnt(4)
    v_mfma_f32_32x32x16_bf16 v[144:159], v[196:199], v[64:67], v[144:159]
    ds_read_b64_tr_b16 v[212:213], v9 offset:3616
    ds_read_b64_tr_b16 v[214:215], v9 offset:4512
    s_waitcnt lgkmcnt(4)
    v_mfma_f32_32x32x16_bf16 v[160:175], v[200:203], v[64:67], v[160:175]
    ds_read_b64_tr_b16 v[216:217], v9 offset:3648
    ds_read_b64_tr_b16 v[218:219], v9 offset:4544
    s_waitcnt lgkmcnt(4)
    v_mfma_f32_32x32x16_bf16 v[128:143], v[208:211], v[68:71], v[128:143]
    v_add_u32 v9, 14848, v8
    ds_read_b64_tr_b16 v[192:193], v9 offset:0
    ds_read_b64_tr_b16 v[194:195], v9 offset:896
    s_waitcnt lgkmcnt(4)
    v_mfma_f32_32x32x16_bf16 v[144:159], v[212:215], v[68:71], v[144:159]
    ds_read_b64_tr_b16 v[196:197], v9 offset:32
    ds_read_b64_tr_b16 v[198:199], v9 offset:928
    s_waitcnt lgkmcnt(4)
    v_mfma_f32_32x32x16_bf16 v[160:175], v[216:219], v[68:71], v[160:175]
    ds_read_b64_tr_b16 v[200:201], v9 offset:64
    ds_read_b64_tr_b16 v[202:203], v9 offset:960
    s_waitcnt lgkmcnt(4)
    v_mfma_f32_32x32x16_bf16 v[128:143], v[192:195], v[72:75], v[128:143]
    ds_read_b64_tr_b16 v[208:209], v9 offset:3584
    ds_read_b64_tr_b16 v[210:211], v9 offset:4480
    s_waitcnt lgkmcnt(4)
    v_mfma_f32_32x32x16_bf16 v[144:159], v[196:199], v[72:75], v[144:159]
    ds_read_b64_tr_b16 v[212:213], v9 offset:3616
    ds_read_b64_tr_b16 v[214:215], v9 offset:4512
    s_waitcnt lgkmcnt(4)
    v_mfma_f32_32x32x16_bf16 v[160:175], v[200:203], v[72:75], v[160:175]
    ds_read_b64_tr_b16 v[216:217], v9 offset:3648
    ds_read_b64_tr_b16 v[218:219], v9 offset:4544
    s_waitcnt lgkmcnt(4)
    v_mfma_f32_32x32x16_bf16 v[128:143], v[208:211], v[76:79], v[128:143]
    s_waitcnt vmcnt(8)
    s_barrier
    v_add_u32 v9, 29696, v8
    ds_read_b64_tr_b16 v[192:193], v9 offset:0
    ds_read_b64_tr_b16 v[194:195], v9 offset:896
    s_waitcnt lgkmcnt(4)
    v_mfma_f32_32x32x16_bf16 v[144:159], v[212:215], v[76:79], v[144:159]
    ds_read_b64_tr_b16 v[196:197], v9 offset:32
    ds_read_b64_tr_b16 v[198:199], v9 offset:928
    s_waitcnt lgkmcnt(4)
    v_mfma_f32_32x32x16_bf16 v[160:175], v[216:219], v[76:79], v[160:175]
    ds_read_b64_tr_b16 v[200:201], v9 offset:64
    ds_read_b64_tr_b16 v[202:203], v9 offset:960
    s_waitcnt lgkmcnt(4)
    v_mfma_f32_32x32x16_bf16 v[128:143], v[192:195], v[80:83], v[128:143]
    ds_read_b64_tr_b16 v[208:209], v9 offset:3584
    ds_read_b64_tr_b16 v[210:211], v9 offset:4480
    s_waitcnt lgkmcnt(4)
    v_mfma_f32_32x32x16_bf16 v[144:159], v[196:199], v[80:83], v[144:159]
    ds_read_b64_tr_b16 v[212:213], v9 offset:3616
    ds_read_b64_tr_b16 v[214:215], v9 offset:4512
    s_waitcnt lgkmcnt(4)
    v_mfma_f32_32x32x16_bf16 v[160:175], v[200:203], v[80:83], v[160:175]
    ds_read_b64_tr_b16 v[216:217], v9 offset:3648
    ds_read_b64_tr_b16 v[218:219], v9 offset:4544
    s_waitcnt lgkmcnt(4)
    v_mfma_f32_32x32x16_bf16 v[128:143], v[208:211], v[84:87], v[128:143]
    v_lshlrev_b32 v243, 4, v1
    v_bfe_u32 v12, v1, 4, 1
    v_lshlrev_b32 v12, 7, v12
    v_xor_b32 v241, v243, v12
    v_add_u32 v9, 44544, v8
    ds_read_b64_tr_b16 v[192:193], v9 offset:0
    ds_read_b64_tr_b16 v[194:195], v9 offset:896
    s_waitcnt lgkmcnt(4)
    v_mfma_f32_32x32x16_bf16 v[144:159], v[212:215], v[84:87], v[144:159]
    ds_read_b64_tr_b16 v[196:197], v9 offset:32
    ds_read_b64_tr_b16 v[198:199], v9 offset:928
    s_waitcnt lgkmcnt(4)
    v_mfma_f32_32x32x16_bf16 v[160:175], v[216:219], v[84:87], v[160:175]
    ds_read_b64_tr_b16 v[200:201], v9 offset:64
    ds_read_b64_tr_b16 v[202:203], v9 offset:960
    s_waitcnt lgkmcnt(4)
    v_mfma_f32_32x32x16_bf16 v[128:143], v[192:195], v[88:91], v[128:143]
    ds_read_b64_tr_b16 v[208:209], v9 offset:3584
    ds_read_b64_tr_b16 v[210:211], v9 offset:4480
    s_waitcnt lgkmcnt(4)
    v_mfma_f32_32x32x16_bf16 v[144:159], v[196:199], v[88:91], v[144:159]
    ds_read_b64_tr_b16 v[212:213], v9 offset:3616
    ds_read_b64_tr_b16 v[214:215], v9 offset:4512
    s_waitcnt lgkmcnt(4)
    v_mfma_f32_32x32x16_bf16 v[160:175], v[200:203], v[88:91], v[160:175]
    ds_read_b64_tr_b16 v[216:217], v9 offset:3648
    ds_read_b64_tr_b16 v[218:219], v9 offset:4544
    s_waitcnt lgkmcnt(4)
    v_mfma_f32_32x32x16_bf16 v[128:143], v[208:211], v[92:95], v[128:143]
    s_cmp_lg_u32 s46, 0
    s_cbranch_scc1 L_kvc_6
    s_waitcnt vmcnt(0)
    s_mov_b64 exec, 0x7f
    v_cmp_ne_u64 vcc, s[90:91], v[252:253]
    s_mov_b64 exec, -1
    s_cmp_eq_u64 vcc, 0
    s_cbranch_scc1 L_kvc_6
    s_mov_b32 s95, 0
    s_mov_b64 exec, 127
L_poll_7:
    buffer_load_dwordx2 v[252:253], v255, s[96:99], 0 offen sc1
    s_waitcnt vmcnt(0)
    v_cmp_ne_u64 vcc, s[90:91], v[252:253]
    s_nop 1
    s_cmp_eq_u64 vcc, 0
    s_cbranch_scc1 L_polld_8
    s_sleep 2
    s_add_u32 s95, s95, 1
    s_cmp_lt_u32 s95, 0x40000
    s_cbranch_scc1 L_poll_7
L_polld_8:
    s_mov_b64 exec, -1
L_kvc_6:
    s_waitcnt vmcnt(4)
    s_barrier
    s_lshl_b32 s49, s44, 17
    s_lshl_b32 s50, s45, 3
    s_mul_i32 s51, s46, 3
    s_add_u32 s50, s50, s51
    s_mul_i32 s51, s46, 3072
    s_add_i32 s61, s50, -16
    s_max_i32 s61, s61, 0
    s_lshl_b32 s61, s61, 10
    s_add_u32 s61, s61, s49
    s_add_u32 s92, s61, 2097152
    s_add_u32 m0, s51, 129536
    s_nop 0
    buffer_load_dwordx4 v243, s[40:43], s92 offen sc1 lds
    s_add_u32 s92, s61, 4194304
    s_add_u32 m0, s51, 0
    s_nop 0
    buffer_load_dwordx4 v241, s[40:43], s92 offen sc1 lds
    s_add_i32 s61, s50, -15
    s_max_i32 s61, s61, 0
    s_lshl_b32 s61, s61, 10
    s_add_u32 s61, s61, s49
    s_add_u32 s92, s61, 2097152
    s_add_u32 m0, s51, 130560
    s_nop 0
    buffer_load_dwordx4 v243, s[40:43], s92 offen sc1 lds
    s_add_u32 s92, s61, 4194304
    s_add_u32 m0, s51, 1024
    s_nop 0
    buffer_load_dwordx4 v241, s[40:43], s92 offen sc1 lds
    s_add_i32 s61, s50, -14
    s_max_i32 s61, s61, 0
    s_lshl_b32 s61, s61, 10
    s_add_u32 s61, s61, s49
    s_add_u32 s92, s61, 2097152
    s_add_u32 m0, s51, 131584
    s_nop 0
    buffer_load_dwordx4 v243, s[40:43], s92 offen sc1 lds
    s_add_u32 s92, s61, 4194304
    s_add_u32 m0, s51, 2048
    s_nop 0
    buffer_load_dwordx4 v241, s[40:43], s92 offen sc1 lds
    s_lshl_b32 s50, s45, 3
    s_add_u32 s50, s50, s46
    s_lshl_b32 s61, s50, 10
    s_add_u32 s61, s61, s49
    buffer_load_dwordx4 v[244:247], v243, s[40:43], s61 offen sc1
    v_add_u32 v9, 59392, v8
    ds_read_b64_tr_b16 v[192:193], v9 offset:0
    ds_read_b64_tr_b16 v[194:195], v9 offset:896
    s_waitcnt lgkmcnt(4)
    v_mfma_f32_32x32x16_bf16 v[144:159], v[212:215], v[92:95], v[144:159]
    ds_read_b64_tr_b16 v[196:197], v9 offset:32
    ds_read_b64_tr_b16 v[198:199], v9 offset:928
    s_waitcnt lgkmcnt(4)
    v_mfma_f32_32x32x16_bf16 v[160:175], v[216:219], v[92:95], v[160:175]
    ds_read_b64_tr_b16 v[200:201], v9 offset:64
    ds_read_b64_tr_b16 v[202:203], v9 offset:960
    s_waitcnt lgkmcnt(4)
    v_mfma_f32_32x32x16_bf16 v[128:143], v[192:195], v[96:99], v[128:143]
    ds_read_b64_tr_b16 v[208:209], v9 offset:3584
    ds_read_b64_tr_b16 v[210:211], v9 offset:4480
    s_waitcnt lgkmcnt(4)
    v_mfma_f32_32x32x16_bf16 v[144:159], v[196:199], v[96:99], v[144:159]
    ds_read_b64_tr_b16 v[212:213], v9 offset:3616
    ds_read_b64_tr_b16 v[214:215], v9 offset:4512
    s_waitcnt lgkmcnt(4)
    v_mfma_f32_32x32x16_bf16 v[160:175], v[200:203], v[96:99], v[160:175]
    ds_read_b64_tr_b16 v[216:217], v9 offset:3648
    ds_read_b64_tr_b16 v[218:219], v9 offset:4544
    s_waitcnt lgkmcnt(4)
    v_mfma_f32_32x32x16_bf16 v[128:143], v[208:211], v[100:103], v[128:143]
    v_add_u32 v9, 74240, v8
    ds_read_b64_tr_b16 v[192:193], v9 offset:0
    ds_read_b64_tr_b16 v[194:195], v9 offset:896
    s_waitcnt lgkmcnt(4)
    v_mfma_f32_32x32x16_bf16 v[144:159], v[212:215], v[100:103], v[144:159]
    ds_read_b64_tr_b16 v[196:197], v9 offset:32
    ds_read_b64_tr_b16 v[198:199], v9 offset:928
    s_waitcnt lgkmcnt(4)
    v_mfma_f32_32x32x16_bf16 v[160:175], v[216:219], v[100:103], v[160:175]
    ds_read_b64_tr_b16 v[200:201], v9 offset:64
    ds_read_b64_tr_b16 v[202:203], v9 offset:960
    s_waitcnt lgkmcnt(4)
    v_mfma_f32_32x32x16_bf16 v[128:143], v[192:195], v[104:107], v[128:143]
    ds_read_b64_tr_b16 v[208:209], v9 offset:3584
    ds_read_b64_tr_b16 v[210:211], v9 offset:4480
    s_waitcnt lgkmcnt(4)
    v_mfma_f32_32x32x16_bf16 v[144:159], v[196:199], v[104:107], v[144:159]
    ds_read_b64_tr_b16 v[212:213], v9 offset:3616
    ds_read_b64_tr_b16 v[214:215], v9 offset:4512
    s_waitcnt lgkmcnt(4)
    v_mfma_f32_32x32x16_bf16 v[160:175], v[200:203], v[104:107], v[160:175]
    ds_read_b64_tr_b16 v[216:217], v9 offset:3648
    ds_read_b64_tr_b16 v[218:219], v9 offset:4544
    s_waitcnt lgkmcnt(4)
    v_mfma_f32_32x32x16_bf16 v[128:143], v[208:211], v[108:111], v[128:143]
    s_waitcnt vmcnt(7)
    s_barrier
    v_add_u32 v9, 89088, v8
    ds_read_b64_tr_b16 v[192:193], v9 offset:0
    ds_read_b64_tr_b16 v[194:195], v9 offset:896
    s_waitcnt lgkmcnt(4)
    v_mfma_f32_32x32x16_bf16 v[144:159], v[212:215], v[108:111], v[144:159]
    ds_read_b64_tr_b16 v[196:197], v9 offset:32
    ds_read_b64_tr_b16 v[198:199], v9 offset:928
    s_waitcnt lgkmcnt(4)
    v_mfma_f32_32x32x16_bf16 v[160:175], v[216:219], v[108:111], v[160:175]
    ds_read_b64_tr_b16 v[200:201], v9 offset:64
    ds_read_b64_tr_b16 v[202:203], v9 offset:960
    s_waitcnt lgkmcnt(4)
    v_mfma_f32_32x32x16_bf16 v[128:143], v[192:195], v[112:115], v[128:143]
    ds_read_b64_tr_b16 v[208:209], v9 offset:3584
    ds_read_b64_tr_b16 v[210:211], v9 offset:4480
    s_waitcnt lgkmcnt(4)
    v_mfma_f32_32x32x16_bf16 v[144:159], v[196:199], v[112:115], v[144:159]
    ds_read_b64_tr_b16 v[212:213], v9 offset:3616
    ds_read_b64_tr_b16 v[214:215], v9 offset:4512
    s_waitcnt lgkmcnt(4)
    v_mfma_f32_32x32x16_bf16 v[160:175], v[200:203], v[112:115], v[160:175]
    ds_read_b64_tr_b16 v[216:217], v9 offset:3648
    ds_read_b64_tr_b16 v[218:219], v9 offset:4544
    s_waitcnt lgkmcnt(4)
    v_mfma_f32_32x32x16_bf16 v[128:143], v[208:211], v[116:119], v[128:143]
    v_add_u32 v9, 114688, v8
    ds_read_b64_tr_b16 v[192:193], v9 offset:0
    ds_read_b64_tr_b16 v[194:195], v9 offset:896
    s_waitcnt lgkmcnt(4)
    v_mfma_f32_32x32x16_bf16 v[144:159], v[212:215], v[116:119], v[144:159]
    ds_read_b64_tr_b16 v[196:197], v9 offset:32
    ds_read_b64_tr_b16 v[198:199], v9 offset:928
    s_waitcnt lgkmcnt(4)
    v_mfma_f32_32x32x16_bf16 v[160:175], v[216:219], v[116:119], v[160:175]
    ds_read_b64_tr_b16 v[200:201], v9 offset:64
    ds_read_b64_tr_b16 v[202:203], v9 offset:960
    s_waitcnt lgkmcnt(4)
    v_mfma_f32_32x32x16_bf16 v[128:143], v[192:195], v[120:123], v[128:143]
    ds_read_b64_tr_b16 v[208:209], v9 offset:3584
    ds_read_b64_tr_b16 v[210:211], v9 offset:4480
    s_waitcnt lgkmcnt(4)
    v_mfma_f32_32x32x16_bf16 v[144:159], v[196:199], v[120:123], v[144:159]
    ds_read_b64_tr_b16 v[212:213], v9 offset:3616
    ds_read_b64_tr_b16 v[214:215], v9 offset:4512
    s_waitcnt lgkmcnt(4)
    v_mfma_f32_32x32x16_bf16 v[160:175], v[200:203], v[120:123], v[160:175]
    ds_read_b64_tr_b16 v[216:217], v9 offset:3648
    ds_read_b64_tr_b16 v[218:219], v9 offset:4544
    s_waitcnt lgkmcnt(4)
    v_mfma_f32_32x32x16_bf16 v[128:143], v[208:211], v[124:127], v[128:143]
    s_waitcnt lgkmcnt(2)
    v_mfma_f32_32x32x16_bf16 v[144:159], v[212:215], v[124:127], v[144:159]
    s_waitcnt lgkmcnt(0)
    v_mfma_f32_32x32x16_bf16 v[160:175], v[216:219], v[124:127], v[160:175]
    v_mov_b32 v15, s58
    s_nop 6
    v_cvt_pk_bf16_f32 v224, v128, v129
    v_cvt_pk_bf16_f32 v228, v136, v137
    v_cvt_pk_bf16_f32 v225, v130, v131
    v_cvt_pk_bf16_f32 v229, v138, v139
    v_cvt_pk_bf16_f32 v226, v132, v133
    v_cvt_pk_bf16_f32 v230, v140, v141
    v_cvt_pk_bf16_f32 v227, v134, v135
    v_cvt_pk_bf16_f32 v231, v142, v143
    v_lshlrev_b32 v128, 16, v224
    v_and_b32 v129, v15, v224
    v_lshlrev_b32 v130, 16, v228
    v_and_b32 v131, v15, v228
    v_lshlrev_b32 v132, 16, v225
    v_and_b32 v133, v15, v225
    v_lshlrev_b32 v134, 16, v229
    v_and_b32 v135, v15, v229
    v_lshlrev_b32 v136, 16, v226
    v_and_b32 v137, v15, v226
    v_lshlrev_b32 v138, 16, v230
    v_and_b32 v139, v15, v230
    v_lshlrev_b32 v140, 16, v227
    v_and_b32 v141, v15, v227
    v_lshlrev_b32 v142, 16, v231
    v_and_b32 v143, v15, v231
    v_mul_f32 v128, v128, v130
    v_mul_f32 v129, v129, v131
    v_mul_f32 v132, v132, v134
    v_mul_f32 v133, v133, v135
    v_mul_f32 v136, v136, v138
    v_mul_f32 v137, v137, v139
    v_mul_f32 v140, v140, v142
    v_mul_f32 v141, v141, v143
    v_cvt_pk_bf16_f32 v192, v128, v129
    v_cvt_pk_bf16_f32 v193, v132, v133
    v_cvt_pk_bf16_f32 v194, v136, v137
    v_cvt_pk_bf16_f32 v195, v140, v141
    s_mov_b32 s50, 0
    buffer_store_dwordx4 v[192:195], v242, s[40:43], s50 offen sc1
    v_cvt_pk_bf16_f32 v224, v144, v145
    v_cvt_pk_bf16_f32 v228, v152, v153
    v_cvt_pk_bf16_f32 v225, v146, v147
    v_cvt_pk_bf16_f32 v229, v154, v155
    v_cvt_pk_bf16_f32 v226, v148, v149
    v_cvt_pk_bf16_f32 v230, v156, v157
    v_cvt_pk_bf16_f32 v227, v150, v151
    v_cvt_pk_bf16_f32 v231, v158, v159
    v_lshlrev_b32 v144, 16, v224
    v_and_b32 v145, v15, v224
    v_lshlrev_b32 v146, 16, v228
    v_and_b32 v147, v15, v228
    v_lshlrev_b32 v148, 16, v225
    v_and_b32 v149, v15, v225
    v_lshlrev_b32 v150, 16, v229
    v_and_b32 v151, v15, v229
    v_lshlrev_b32 v152, 16, v226
    v_and_b32 v153, v15, v226
    v_lshlrev_b32 v154, 16, v230
    v_and_b32 v155, v15, v230
    v_lshlrev_b32 v156, 16, v227
    v_and_b32 v157, v15, v227
    v_lshlrev_b32 v158, 16, v231
    v_and_b32 v159, v15, v231
    v_mul_f32 v144, v144, v146
    v_mul_f32 v145, v145, v147
    v_mul_f32 v148, v148, v150
    v_mul_f32 v149, v149, v151
    v_mul_f32 v152, v152, v154
    v_mul_f32 v153, v153, v155
    v_mul_f32 v156, v156, v158
    v_mul_f32 v157, v157, v159
    v_cvt_pk_bf16_f32 v196, v144, v145
    v_cvt_pk_bf16_f32 v197, v148, v149
    v_cvt_pk_bf16_f32 v198, v152, v153
    v_cvt_pk_bf16_f32 v199, v156, v157
    s_mov_b32 s50, 1024
    buffer_store_dwordx4 v[196:199], v242, s[40:43], s50 offen sc1
    v_cvt_pk_bf16_f32 v224, v160, v161
    v_cvt_pk_bf16_f32 v228, v168, v169
    v_cvt_pk_bf16_f32 v225, v162, v163
    v_cvt_pk_bf16_f32 v229, v170, v171
    v_cvt_pk_bf16_f32 v226, v164, v165
    v_cvt_pk_bf16_f32 v230, v172, v173
    v_cvt_pk_bf16_f32 v227, v166, v167
    v_cvt_pk_bf16_f32 v231, v174, v175
    v_lshlrev_b32 v160, 16, v224
    v_and_b32 v161, v15, v224
    v_lshlrev_b32 v162, 16, v228
    v_and_b32 v163, v15, v228
    v_lshlrev_b32 v164, 16, v225
    v_and_b32 v165, v15, v225
    v_lshlrev_b32 v166, 16, v229
    v_and_b32 v167, v15, v229
    v_lshlrev_b32 v168, 16, v226
    v_and_b32 v169, v15, v226
    v_lshlrev_b32 v170, 16, v230
    v_and_b32 v171, v15, v230
    v_lshlrev_b32 v172, 16, v227
    v_and_b32 v173, v15, v227
    v_lshlrev_b32 v174, 16, v231
    v_and_b32 v175, v15, v231
    v_mul_f32 v160, v160, v162
    v_mul_f32 v161, v161, v163
    v_mul_f32 v164, v164, v166
    v_mul_f32 v165, v165, v167
    v_mul_f32 v168, v168, v170
    v_mul_f32 v169, v169, v171
    v_mul_f32 v172, v172, v174
    v_mul_f32 v173, v173, v175
    v_cvt_pk_bf16_f32 v200, v160, v161
    v_cvt_pk_bf16_f32 v201, v164, v165
    v_cvt_pk_bf16_f32 v202, v168, v169
    v_cvt_pk_bf16_f32 v203, v172, v173
    s_mov_b32 s50, 2048
    buffer_store_dwordx4 v[200:203], v242, s[40:43], s50 offen sc1
    s_branch L_s1_join
L_s1_ch1:
    s_nop 1
    s_waitcnt vmcnt(8)
    s_barrier
    v_add_u32 v9, 114688, v7
    ds_read_b64_tr_b16 v[192:193], v9 offset:112
    ds_read_b64_tr_b16 v[194:195], v9 offset:880
    s_waitcnt lgkmcnt(0)
    v_mfma_f32_32x32x16_bf16 v[128:143], v[192:195], v[16:19], 0
    ds_read_b64_tr_b16 v[208:209], v9 offset:3184
    ds_read_b64_tr_b16 v[210:211], v9 offset:3952
    s_waitcnt lgkmcnt(0)
    v_mfma_f32_32x32x16_bf16 v[128:143], v[208:211], v[20:23], v[128:143]
    ds_read_b64_tr_b16 v[192:193], v9 offset:6256
    ds_read_b64_tr_b16 v[194:195], v9 offset:7024
    s_waitcnt lgkmcnt(0)
    v_mfma_f32_32x32x16_bf16 v[128:143], v[192:195], v[24:27], v[128:143]
    ds_read_b64_tr_b16 v[208:209], v9 offset:9328
    ds_read_b64_tr_b16 v[210:211], v9 offset:10096
    s_waitcnt lgkmcnt(0)
    v_mfma_f32_32x32x16_bf16 v[128:143], v[208:211], v[28:31], v[128:143]
    s_waitcnt vmcnt(6)
    s_barrier
    v_add_u32 v9, 129536, v7
    ds_read_b64_tr_b16 v[192:193], v9 offset:112
    ds_read_b64_tr_b16 v[194:195], v9 offset:880
    s_waitcnt lgkmcnt(0)
    v_mfma_f32_32x32x16_bf16 v[128:143], v[192:195], v[32:35], v[128:143]
    s_mov_b64 exec, s[52:53]
    s_add_u32 m0, s59, 29696
    s_mov_b32 s50, 860160
    buffer_load_dwordx4 v5, s[28:31], s50 offen lds
    s_add_u32 m0, s59, 30464
    s_mov_b32 s50, 870912
    buffer_load_dwordx4 v5, s[28:31], s50 offen lds
    s_mov_b64 exec, -1
    s_mov_b64 exec, s[52:53]
    s_add_u32 m0, s59, 44544
    s_mov_b32 s50, 1032192
    buffer_load_dwordx4 v5, s[28:31], s50 offen lds
    s_add_u32 m0, s59, 45312
    s_mov_b32 s50, 1042944
    buffer_load_dwordx4 v5, s[28:31], s50 offen lds
    s_mov_b64 exec, -1
    s_mov_b64 exec, s[54:55]
    s_mov_b32 s50, 0
    s_add_u32 m0, s60, 59392
    s_nop 0
    buffer_load_dwordx4 v6, s[32:35], s50 offen lds
    s_add_u32 m0, s60, 66688
    s_nop 0
    buffer_load_dwordx4 v6, s[36:39], s50 offen lds
    s_mov_b64 exec, -1
    ds_read_b64_tr_b16 v[208:209], v9 offset:3184
    ds_read_b64_tr_b16 v[210:211], v9 offset:3952
    s_waitcnt lgkmcnt(0)
    v_mfma_f32_32x32x16_bf16 v[128:143], v[208:211], v[36:39], v[128:143]
    ds_read_b64_tr_b16 v[192:193], v9 offset:6256
    ds_read_b64_tr_b16 v[194:195], v9 offset:7024
    s_waitcnt lgkmcnt(0)
    v_mfma_f32_32x32x16_bf16 v[128:143], v[192:195], v[40:43], v[128:143]
    ds_read_b64_tr_b16 v[208:209], v9 offset:9328
    ds_read_b64_tr_b16 v[210:211], v9 offset:10096
    s_waitcnt lgkmcnt(0)
    v_mfma_f32_32x32x16_bf16 v[128:143], v[208:211], v[44:47], v[128:143]
    s_waitcnt vmcnt(10)
    s_barrier
    v_add_u32 v9, 144384, v7
    ds_read_b64_tr_b16 v[192:193], v9 offset:112
    ds_read_b64_tr_b16 v[194:195], v9 offset:880
    s_waitcnt lgkmcnt(0)
    v_mfma_f32_32x32x16_bf16 v[128:143], v[192:195], v[48:51], v[128:143]
    s_mov_b64 exec, s[54:55]
    s_mov_b32 s50, 114688
    s_add_u32 m0, s60, 74240
    s_nop 0
    buffer_load_dwordx4 v6, s[32:35], s50 offen lds
    s_add_u32 m0, s60, 81536
    s_nop 0
    buffer_load_dwordx4 v6, s[36:39], s50 offen lds
    s_mov_b64 exec, -1
    s_mov_b64 exec, s[54:55]
    s_mov_b32 s50, 229376
    s_add_u32 m0, s60, 89088
    s_nop 0
    buffer_load_dwordx4 v6, s[32:35], s50 offen lds
    s_add_u32 m0, s60, 96384
    s_nop 0
    buffer_load_dwordx4 v6, s[36:39], s50 offen lds
    s_mov_b64 exec, -1
    s_mov_b64 exec, s[54:55]
    s_mov_b32 s50, 344064
    s_add_u32 m0, s60, 114688
    s_nop 0
    buffer_load_dwordx4 v6, s[32:35], s50 offen lds
    s_add_u32 m0, s60, 121984
    s_nop 0
    buffer_load_dwordx4 v6, s[36:39], s50 offen lds
    s_mov_b64 exec, -1
    ds_read_b64_tr_b16 v[208:209], v9 offset:3184
    ds_read_b64_tr_b16 v[210:211], v9 offset:3952
    s_waitcnt lgkmcnt(0)
    v_mfma_f32_32x32x16_bf16 v[128:143], v[208:211], v[52:55], v[128:143]
    ds_read_b64_tr_b16 v[192:193], v9 offset:6256
    ds_read_b64_tr_b16 v[194:195], v9 offset:7024
    s_waitcnt lgkmcnt(0)
    v_mfma_f32_32x32x16_bf16 v[128:143], v[192:195], v[56:59], v[128:143]
    ds_read_b64_tr_b16 v[208:209], v9 offset:9328
    ds_read_b64_tr_b16 v[210:211], v9 offset:10096
    s_waitcnt lgkmcnt(0)
    v_mfma_f32_32x32x16_bf16 v[128:143], v[208:211], v[60:63], v[128:143]
    s_waitcnt vmcnt(14)
    s_barrier
    v_add_u32 v9, 0, v7
    ds_read_b64_tr_b16 v[192:193], v9 offset:112
    ds_read_b64_tr_b16 v[194:195], v9 offset:880
    s_waitcnt lgkmcnt(0)
    v_mfma_f32_32x32x16_bf16 v[128:143], v[192:195], v[64:67], v[128:143]
    s_mov_b64 exec, s[54:55]
    s_mov_b32 s50, 458752
    s_add_u32 m0, s60, 129536
    s_nop 0
    buffer_load_dwordx4 v6, s[32:35], s50 offen lds
    s_add_u32 m0, s60, 136832
    s_nop 0
    buffer_load_dwordx4 v6, s[36:39], s50 offen lds
    s_mov_b64 exec, -1
    ds_read_b64_tr_b16 v[208:209], v9 offset:3184
    ds_read_b64_tr_b16 v[210:211], v9 offset:3952
    s_waitcnt lgkmcnt(0)
    v_mfma_f32_32x32x16_bf16 v[128:143], v[208:211], v[68:71], v[128:143]
    ds_read_b64_tr_b16 v[192:193], v9 offset:6256
    ds_read_b64_tr_b16 v[194:195], v9 offset:7024
    s_waitcnt lgkmcnt(0)
    v_mfma_f32_32x32x16_bf16 v[128:143], v[192:195], v[72:75], v[128:143]
    ds_read_b64_tr_b16 v[208:209], v9 offset:9328
    ds_read_b64_tr_b16 v[210:211], v9 offset:10096
    s_waitcnt lgkmcnt(0)
    v_mfma_f32_32x32x16_bf16 v[128:143], v[208:211], v[76:79], v[128:143]
    s_waitcnt vmcnt(14)
    s_barrier
    v_add_u32 v9, 14848, v7
    ds_read_b64_tr_b16 v[192:193], v9 offset:112
    ds_read_b64_tr_b16 v[194:195], v9 offset:880
    s_waitcnt lgkmcnt(0)
    v_mfma_f32_32x32x16_bf16 v[128:143], v[192:195], v[80:83], v[128:143]
    s_mov_b64 exec, s[54:55]
    s_mov_b32 s50, 573440
    s_add_u32 m0, s60, 144384
    s_nop 0
    buffer_load_dwordx4 v6, s[32:35], s50 offen lds
    s_add_u32 m0, s60, 151680
    s_nop 0
    buffer_load_dwordx4 v6, s[36:39], s50 offen lds
    s_mov_b64 exec, -1
    ds_read_b64_tr_b16 v[208:209], v9 offset:3184
    ds_read_b64_tr_b16 v[210:211], v9 offset:3952
    s_waitcnt lgkmcnt(0)
    v_mfma_f32_32x32x16_bf16 v[128:143], v[208:211], v[84:87], v[128:143]
    ds_read_b64_tr_b16 v[192:193], v9 offset:6256
    ds_read_b64_tr_b16 v[194:195], v9 offset:7024
    s_waitcnt lgkmcnt(0)
    v_mfma_f32_32x32x16_bf16 v[128:143], v[192:195], v[88:91], v[128:143]
    ds_read_b64_tr_b16 v[208:209], v9 offset:9328
    ds_read_b64_tr_b16 v[210:211], v9 offset:10096
    s_waitcnt lgkmcnt(0)
    v_mfma_f32_32x32x16_bf16 v[128:143], v[208:211], v[92:95], v[128:143]
    s_waitcnt vmcnt(14)
    s_barrier
    v_add_u32 v9, 29696, v7
    ds_read_b64_tr_b16 v[192:193], v9 offset:112
    ds_read_b64_tr_b16 v[194:195], v9 offset:880
    s_waitcnt lgkmcnt(0)
    v_mfma_f32_32x32x16_bf16 v[128:143], v[192:195], v[96:99], v[128:143]
    s_mov_b64 exec, s[54:55]
    s_mov_b32 s50, 688128
    s_add_u32 m0, s60, 0
    s_nop 0
    buffer_load_dwordx4 v6, s[32:35], s50 offen lds
    s_add_u32 m0, s60, 7296
    s_nop 0
    buffer_load_dwordx4 v6, s[36:39], s50 offen lds
    s_mov_b64 exec, -1
    ds_read_b64_tr_b16 v[208:209], v9 offset:3184
    ds_read_b64_tr_b16 v[210:211], v9 offset:3952
    s_waitcnt lgkmcnt(0)
    v_mfma_f32_32x32x16_bf16 v[128:143], v[208:211], v[100:103], v[128:143]
    ds_read_b64_tr_b16 v[192:193], v9 offset:6256
    ds_read_b64_tr_b16 v[194:195], v9 offset:7024
    s_waitcnt lgkmcnt(0)
    v_mfma_f32_32x32x16_bf16 v[128:143], v[192:195], v[104:107], v[128:143]
    ds_read_b64_tr_b16 v[208:209], v9 offset:9328
    ds_read_b64_tr_b16 v[210:211], v9 offset:10096
    s_waitcnt lgkmcnt(0)
    v_mfma_f32_32x32x16_bf16 v[128:143], v[208:211], v[108:111], v[128:143]
    s_waitcnt vmcnt(14)
    s_barrier
    v_add_u32 v9, 44544, v7
    ds_read_b64_tr_b16 v[192:193], v9 offset:112
    ds_read_b64_tr_b16 v[194:195], v9 offset:880
    s_waitcnt lgkmcnt(0)
    v_mfma_f32_32x32x16_bf16 v[128:143], v[192:195], v[112:115], v[128:143]
    s_mov_b64 exec, s[54:55]
    s_mov_b32 s50, 802816
    s_add_u32 m0, s60, 14848
    s_nop 0
    buffer_load_dwordx4 v6, s[32:35], s50 offen lds
    s_add_u32 m0, s60, 22144
    s_nop 0
    buffer_load_dwordx4 v6, s[36:39], s50 offen lds
    s_mov_b64 exec, -1
    ds_read_b64_tr_b16 v[208:209], v9 offset:3184
    ds_read_b64_tr_b16 v[210:211], v9 offset:3952
    s_waitcnt lgkmcnt(0)
    v_mfma_f32_32x32x16_bf16 v[128:143], v[208:211], v[116:119], v[128:143]
    ds_read_b64_tr_b16 v[192:193], v9 offset:6256
    ds_read_b64_tr_b16 v[194:195], v9 offset:7024
    s_waitcnt lgkmcnt(0)
    v_mfma_f32_32x32x16_bf16 v[128:143], v[192:195], v[120:123], v[128:143]
    ds_read_b64_tr_b16 v[208:209], v9 offset:9328
    ds_read_b64_tr_b16 v[210:211], v9 offset:10096
    s_waitcnt lgkmcnt(0)
    v_mfma_f32_32x32x16_bf16 v[128:143], v[208:211], v[124:127], v[128:143]
    s_cmp_lg_u32 s46, 0
    s_cbranch_scc1 L_nonf_9
    v_readfirstlane_b32 s92, v248
    v_readfirstlane_b32 s93, v249
    s_nop 3
    s_cmp_eq_u64 s[92:93], 0
    s_cselect_b32 s90, s90, s92
    s_cselect_b32 s91, s91, s93
    v_mov_b32 v248, s90
    v_mov_b32 v249, s91
    v_mov_b32 v252, 159232
    ds_write_b64 v252, v[248:249]
    v_mov_b32 v248, 0
    v_mov_b32 v249, 0
    ds_write_b64 v252, v[248:249] offset:8
    s_waitcnt lgkmcnt(0)
L_nonf_9:
    s_waitcnt vmcnt(12)
    s_barrier
    v_add_u32 v9, 59392, v8
    ds_read_b64_tr_b16 v[192:193], v9 offset:96
    ds_read_b64_tr_b16 v[194:195], v9 offset:992
    ds_read_b64_tr_b16 v[196:197], v9 offset:128
    ds_read_b64_tr_b16 v[198:199], v9 offset:1024
    ds_read_b64_tr_b16 v[200:201], v9 offset:160
    ds_read_b64_tr_b16 v[202:203], v9 offset:1056
    ds_read_b64_tr_b16 v[204:205], v9 offset:192
    ds_read_b64_tr_b16 v[206:207], v9 offset:1088
    s_mul_i32 s49, s44, 3
    s_add_u32 s49, s49, 2
    s_lshl_b32 s50, s49, 17
    s_cmp_ge_u32 s49, 32
    s_cselect_b32 s51, 0x3f803f80, 0
    v_mov_b32 v12, s51
    v_cvt_pk_bf16_f32 v224, v128, v129
    v_cvt_pk_bf16_f32 v225, v130, v131
    v_cvt_pk_bf16_f32 v226, v132, v133
    v_cvt_pk_bf16_f32 v227, v134, v135
    v_cvt_pk_bf16_f32 v228, v136, v137
    v_cvt_pk_bf16_f32 v229, v138, v139
    v_cvt_pk_bf16_f32 v230, v140, v141
    v_cvt_pk_bf16_f32 v231, v142, v143
    v_cndmask_b32 v230, v230, v12, s[62:63]
    v_cndmask_b32 v231, v231, v12, s[62:63]
    buffer_store_dwordx4 v[224:227], v240, s[40:43], s50 offen sc1
    buffer_store_dwordx4 v[228:231], v240, s[40:43], s50 offen offset:256 sc1
    s_waitcnt lgkmcnt(6)
    v_mfma_f32_32x32x16_bf16 v[128:143], v[192:195], v[16:19], 0
    ds_read_b64_tr_b16 v[208:209], v9 offset:3680
    ds_read_b64_tr_b16 v[210:211], v9 offset:4576
    s_waitcnt lgkmcnt(6)
    v_mfma_f32_32x32x16_bf16 v[144:159], v[196:199], v[16:19], 0
    ds_read_b64_tr_b16 v[212:213], v9 offset:3712
    ds_read_b64_tr_b16 v[214:215], v9 offset:4608
    s_waitcnt lgkmcnt(6)
    v_mfma_f32_32x32x16_bf16 v[160:175], v[200:203], v[16:19], 0
    ds_read_b64_tr_b16 v[216:217], v9 offset:3744
    ds_read_b64_tr_b16 v[218:219], v9 offset:4640
    s_waitcnt lgkmcnt(6)
    v_mfma_f32_32x32x16_bf16 v[176:191], v[204:207], v[16:19], 0
    s_mov_b64 exec, s[54:55]
    s_mov_b32 s50, 917504
    s_add_u32 m0, s60, 29696
    s_nop 0
    buffer_load_dwordx4 v6, s[32:35], s50 offen lds
    s_add_u32 m0, s60, 36992
    s_nop 0
    buffer_load_dwordx4 v6, s[36:39], s50 offen lds
    s_mov_b64 exec, -1
    ds_read_b64_tr_b16 v[220:221], v9 offset:3776
    ds_read_b64_tr_b16 v[222:223], v9 offset:4672
    s_waitcnt lgkmcnt(6)
    v_mfma_f32_32x32x16_bf16 v[128:143], v[208:211], v[20:23], v[128:143]
    v_add_u32 v9, 74240, v8
    ds_read_b64_tr_b16 v[192:193], v9 offset:96
    ds_read_b64_tr_b16 v[194:195], v9 offset:992
    s_waitcnt lgkmcnt(6)
    v_mfma_f32_32x32x16_bf16 v[144:159], v[212:215], v[20:23], v[144:159]
    ds_read_b64_tr_b16 v[196:197], v9 offset:128
    ds_read_b64_tr_b16 v[198:199], v9 offset:1024
    s_waitcnt lgkmcnt(6)
    v_mfma_f32_32x32x16_bf16 v[160:175], v[216:219], v[20:23], v[160:175]
    ds_read_b64_tr_b16 v[200:201], v9 offset:160
    ds_read_b64_tr_b16 v[202:203], v9 offset:1056
    s_waitcnt lgkmcnt(6)
    v_mfma_f32_32x32x16_bf16 v[176:191], v[220:223], v[20:23], v[176:191]
    ds_read_b64_tr_b16 v[204:205], v9 offset:192
    ds_read_b64_tr_b16 v[206:207], v9 offset:1088
    s_waitcnt lgkmcnt(6)
    v_mfma_f32_32x32x16_bf16 v[128:143], v[192:195], v[24:27], v[128:143]
    ds_read_b64_tr_b16 v[208:209], v9 offset:3680
    ds_read_b64_tr_b16 v[210:211], v9 offset:4576
    s_waitcnt lgkmcnt(6)
    v_mfma_f32_32x32x16_bf16 v[144:159], v[196:199], v[24:27], v[144:159]
    ds_read_b64_tr_b16 v[212:213], v9 offset:3712
    ds_read_b64_tr_b16 v[214:215], v9 offset:4608
    s_waitcnt lgkmcnt(6)
    v_mfma_f32_32x32x16_bf16 v[160:175], v[200:203], v[24:27], v[160:175]
    ds_read_b64_tr_b16 v[216:217], v9 offset:3744
    ds_read_b64_tr_b16 v[218:219], v9 offset:4640
    s_waitcnt lgkmcnt(6)
    v_mfma_f32_32x32x16_bf16 v[176:191], v[204:207], v[24:27], v[176:191]
    ds_read_b64_tr_b16 v[220:221], v9 offset:3776
    ds_read_b64_tr_b16 v[222:223], v9 offset:4672
    s_waitcnt lgkmcnt(6)
    v_mfma_f32_32x32x16_bf16 v[128:143], v[208:211], v[28:31], v[128:143]
    s_waitcnt vmcnt(2)
    s_waitcnt vmcnt(12)
    s_barrier
    s_cmp_lg_u32 s46, 0
    s_cbranch_scc1 L_pub_10
    s_lshl_b32 s92, s94, 3
    s_add_u32 s92, s92, 25165824
    v_mov_b32 v248, s90
    v_mov_b32 v249, s91
    v_mov_b32 v255, s92
    s_mov_b64 exec, 1
    buffer_store_dwordx2 v[248:249], v255, s[96:99], 0 offen sc1
    s_mov_b64 exec, -1
L_pub_10:
    v_add_u32 v9, 89088, v8
    ds_read_b64_tr_b16 v[192:193], v9 offset:96
    ds_read_b64_tr_b16 v[194:195], v9 offset:992
    s_waitcnt lgkmcnt(6)
    v_mfma_f32_32x32x16_bf16 v[144:159], v[212:215], v[28:31], v[144:159]
    ds_read_b64_tr_b16 v[196:197], v9 offset:128
    ds_read_b64_tr_b16 v[198:199], v9 offset:1024
    s_waitcnt lgkmcnt(6)
    v_mfma_f32_32x32x16_bf16 v[160:175], v[216:219], v[28:31], v[160:175]
    ds_read_b64_tr_b16 v[200:201], v9 offset:160
    ds_read_b64_tr_b16 v[202:203], v9 offset:1056
    s_waitcnt lgkmcnt(6)
    v_mfma_f32_32x32x16_bf16 v[176:191], v[220:223], v[28:31], v[176:191]
    ds_read_b64_tr_b16 v[204:205], v9 offset:192
    ds_read_b64_tr_b16 v[206:207], v9 offset:1088
    s_waitcnt lgkmcnt(6)
    v_mfma_f32_32x32x16_bf16 v[128:143], v[192:195], v[32:35], v[128:143]
    ds_read_b64_tr_b16 v[208:209], v9 offset:3680
    ds_read_b64_tr_b16 v[210:211], v9 offset:4576
    s_waitcnt lgkmcnt(6)
    v_mfma_f32_32x32x16_bf16 v[144:159], v[196:199], v[32:35], v[144:159]
    ds_read_b64_tr_b16 v[212:213], v9 offset:3712
    ds_read_b64_tr_b16 v[214:215], v9 offset:4608
    s_waitcnt lgkmcnt(6)
    v_mfma_f32_32x32x16_bf16 v[160:175], v[200:203], v[32:35], v[160:175]
    ds_read_b64_tr_b16 v[216:217], v9 offset:3744
    ds_read_b64_tr_b16 v[218:219], v9 offset:4640
    s_waitcnt lgkmcnt(6)
    v_mfma_f32_32x32x16_bf16 v[176:191], v[204:207], v[32:35], v[176:191]
    s_mov_b64 exec, s[54:55]
    s_mov_b32 s50, 1032192
    s_add_u32 m0, s60, 44544
    s_nop 0
    buffer_load_dwordx4 v6, s[32:35], s50 offen lds
    s_add_u32 m0, s60, 51840
    s_nop 0
    buffer_load_dwordx4 v6, s[36:39], s50 offen lds
    s_mov_b64 exec, -1
    s_mov_b64 exec, s[54:55]
    s_mov_b32 s50, 1146880
    s_add_u32 m0, s60, 59392
    s_nop 0
    buffer_load_dwordx4 v6, s[32:35], s50 offen lds
    s_add_u32 m0, s60, 66688
    s_nop 0
    buffer_load_dwordx4 v6, s[36:39], s50 offen lds
    s_mov_b64 exec, -1
    ds_read_b64_tr_b16 v[220:221], v9 offset:3776
    ds_read_b64_tr_b16 v[222:223], v9 offset:4672
    s_waitcnt lgkmcnt(6)
    v_mfma_f32_32x32x16_bf16 v[128:143], v[208:211], v[36:39], v[128:143]
    v_add_u32 v9, 114688, v8
    ds_read_b64_tr_b16 v[192:193], v9 offset:96
    ds_read_b64_tr_b16 v[194:195], v9 offset:992
    s_waitcnt lgkmcnt(6)
    v_mfma_f32_32x32x16_bf16 v[144:159], v[212:215], v[36:39], v[144:159]
    ds_read_b64_tr_b16 v[196:197], v9 offset:128
    ds_read_b64_tr_b16 v[198:199], v9 offset:1024
    s_waitcnt lgkmcnt(6)
    v_mfma_f32_32x32x16_bf16 v[160:175], v[216:219], v[36:39], v[160:175]
    ds_read_b64_tr_b16 v[200:201], v9 offset:160
    ds_read_b64_tr_b16 v[202:203], v9 offset:1056
    s_waitcnt lgkmcnt(6)
    v_mfma_f32_32x32x16_bf16 v[176:191], v[220:223], v[36:39], v[176:191]
    ds_read_b64_tr_b16 v[204:205], v9 offset:192
    ds_read_b64_tr_b16 v[206:207], v9 offset:1088
    s_waitcnt lgkmcnt(6)
    v_mfma_f32_32x32x16_bf16 v[128:143], v[192:195], v[40:43], v[128:143]
    ds_read_b64_tr_b16 v[208:209], v9 offset:3680
    ds_read_b64_tr_b16 v[210:211], v9 offset:4576
    s_waitcnt lgkmcnt(6)
    v_mfma_f32_32x32x16_bf16 v[144:159], v[196:199], v[40:43], v[144:159]
    ds_read_b64_tr_b16 v[212:213], v9 offset:3712
    ds_read_b64_tr_b16 v[214:215], v9 offset:4608
    s_waitcnt lgkmcnt(6)
    v_mfma_f32_32x32x16_bf16 v[160:175], v[200:203], v[40:43], v[160:175]
    ds_read_b64_tr_b16 v[216:217], v9 offset:3744
    ds_read_b64_tr_b16 v[218:219], v9 offset:4640
    s_waitcnt lgkmcnt(6)
    v_mfma_f32_32x32x16_bf16 v[176:191], v[204:207], v[40:43], v[176:191]
    ds_read_b64_tr_b16 v[220:221], v9 offset:3776
    ds_read_b64_tr_b16 v[222:223], v9 offset:4672
    s_waitcnt lgkmcnt(6)
    v_mfma_f32_32x32x16_bf16 v[128:143], v[208:211], v[44:47], v[128:143]
    s_waitcnt vmcnt(12)
    s_barrier
    v_add_u32 v9, 129536, v8
    ds_read_b64_tr_b16 v[192:193], v9 offset:96
    ds_read_b64_tr_b16 v[194:195], v9 offset:992
    s_waitcnt lgkmcnt(6)
    v_mfma_f32_32x32x16_bf16 v[144:159], v[212:215], v[44:47], v[144:159]
    ds_read_b64_tr_b16 v[196:197], v9 offset:128
    ds_read_b64_tr_b16 v[198:199], v9 offset:1024
    s_waitcnt lgkmcnt(6)
    v_mfma_f32_32x32x16_bf16 v[160:175], v[216:219], v[44:47], v[160:175]
    ds_read_b64_tr_b16 v[200:201], v9 offset:160
    ds_read_b64_tr_b16 v[202:203], v9 offset:1056
    s_waitcnt lgkmcnt(6)
    v_mfma_f32_32x32x16_bf16 v[176:191], v[220:223], v[44:47], v[176:191]
    ds_read_b64_tr_b16 v[204:205], v9 offset:192
    ds_read_b64_tr_b16 v[206:207], v9 offset:1088
    s_waitcnt lgkmcnt(6)
    v_mfma_f32_32x32x16_bf16 v[128:143], v[192:195], v[48:51], v[128:143]
    ds_read_b64_tr_b16 v[208:209], v9 offset:3680
    ds_read_b64_tr_b16 v[210:211], v9 offset:4576
    s_waitcnt lgkmcnt(6)
    v_mfma_f32_32x32x16_bf16 v[144:159], v[196:199], v[48:51], v[144:159]
    ds_read_b64_tr_b16 v[212:213], v9 offset:3712
    ds_read_b64_tr_b16 v[214:215], v9 offset:4608
    s_waitcnt lgkmcnt(6)
    v_mfma_f32_32x32x16_bf16 v[160:175], v[200:203], v[48:51], v[160:175]
    ds_read_b64_tr_b16 v[216:217], v9 offset:3744
    ds_read_b64_tr_b16 v[218:219], v9 offset:4640
    s_waitcnt lgkmcnt(6)
    v_mfma_f32_32x32x16_bf16 v[176:191], v[204:207], v[48:51], v[176:191]
    s_mov_b64 exec, s[54:55]
    s_mov_b32 s50, 1261568
    s_add_u32 m0, s60, 74240
    s_nop 0
    buffer_load_dwordx4 v6, s[32:35], s50 offen lds
    s_add_u32 m0, s60, 81536
    s_nop 0
    buffer_load_dwordx4 v6, s[36:39], s50 offen lds
    s_mov_b64 exec, -1
    s_mov_b64 exec, s[54:55]
    s_mov_b32 s50, 1376256
    s_add_u32 m0, s60, 89088
    s_nop 0
    buffer_load_dwordx4 v6, s[32:35], s50 offen lds
    s_add_u32 m0, s60, 96384
    s_nop 0
    buffer_load_dwordx4 v6, s[36:39], s50 offen lds
    s_mov_b64 exec, -1
    ds_read_b64_tr_b16 v[220:221], v9 offset:3776
    ds_read_b64_tr_b16 v[222:223], v9 offset:4672
    s_waitcnt lgkmcnt(6)
    v_mfma_f32_32x32x16_bf16 v[128:143], v[208:211], v[52:55], v[128:143]
    v_add_u32 v9, 144384, v8
    ds_read_b64_tr_b16 v[192:193], v9 offset:96
    ds_read_b64_tr_b16 v[194:195], v9 offset:992
    s_waitcnt lgkmcnt(6)
    v_mfma_f32_32x32x16_bf16 v[144:159], v[212:215], v[52:55], v[144:159]
    ds_read_b64_tr_b16 v[196:197], v9 offset:128
    ds_read_b64_tr_b16 v[198:199], v9 offset:1024
    s_waitcnt lgkmcnt(6)
    v_mfma_f32_32x32x16_bf16 v[160:175], v[216:219], v[52:55], v[160:175]
    ds_read_b64_tr_b16 v[200:201], v9 offset:160
    ds_read_b64_tr_b16 v[202:203], v9 offset:1056
    s_waitcnt lgkmcnt(6)
    v_mfma_f32_32x32x16_bf16 v[176:191], v[220:223], v[52:55], v[176:191]
    ds_read_b64_tr_b16 v[204:205], v9 offset:192
    ds_read_b64_tr_b16 v[206:207], v9 offset:1088
    s_waitcnt lgkmcnt(6)
    v_mfma_f32_32x32x16_bf16 v[128:143], v[192:195], v[56:59], v[128:143]
    ds_read_b64_tr_b16 v[208:209], v9 offset:3680
    ds_read_b64_tr_b16 v[210:211], v9 offset:4576
    s_waitcnt lgkmcnt(6)
    v_mfma_f32_32x32x16_bf16 v[144:159], v[196:199], v[56:59], v[144:159]
    ds_read_b64_tr_b16 v[212:213], v9 offset:3712
    ds_read_b64_tr_b16 v[214:215], v9 offset:4608
    s_waitcnt lgkmcnt(6)
    v_mfma_f32_32x32x16_bf16 v[160:175], v[200:203], v[56:59], v[160:175]
    ds_read_b64_tr_b16 v[216:217], v9 offset:3744
    ds_read_b64_tr_b16 v[218:219], v9 offset:4640
    s_waitcnt lgkmcnt(6)
    v_mfma_f32_32x32x16_bf16 v[176:191], v[204:207], v[56:59], v[176:191]
    ds_read_b64_tr_b16 v[220:221], v9 offset:3776
    ds_read_b64_tr_b16 v[222:223], v9 offset:4672
    s_waitcnt lgkmcnt(6)
    v_mfma_f32_32x32x16_bf16 v[128:143], v[208:211], v[60:63], v[128:143]
    s_waitcnt vmcnt(12)
    s_barrier
    s_cmp_lg_u32 s46, 0
    s_cbranch_scc1 L_kvp_11
    v_add_u32 v12, 1, v1
    v_lshrrev_b32 v13, 1, v12
    v_subrev_u32 v13, 1, v13
    v_max_i32 v13, 0, v13
    v_and_b32 v14, 1, v1
    v_sub_u32 v14, 2, v14
    v_cmp_eq_u32 vcc, 0, v1
    s_nop 1
    v_cndmask_b32 v14, v14, 0, vcc
    v_lshlrev_b32 v14, 4, v14
    v_add_u32 v14, s44, v14
    v_mul_u32_u24 v14, 43, v14
    v_lshrrev_b32 v14, 7, v14
    v_sub_u32 v13, s45, v13
    v_max_i32 v13, 0, v13
    v_lshl_add_u32 v13, v13, 4, v14
    v_lshlrev_b32 v255, 3, v13
    v_add_u32 v255, 25165824, v255
    s_mov_b64 exec, 0x7f
    buffer_load_dwordx2 v[252:253], v255, s[96:99], 0 offen sc1
    s_mov_b64 exec, -1
L_kvp_11:
    v_add_u32 v9, 0, v8
    ds_read_b64_tr_b16 v[192:193], v9 offset:96
    ds_read_b64_tr_b16 v[194:195], v9 offset:992
    s_waitcnt lgkmcnt(6)
    v_mfma_f32_32x32x16_bf16 v[144:159], v[212:215], v[60:63], v[144:159]
    ds_read_b64_tr_b16 v[196:197], v9 offset:128
    ds_read_b64_tr_b16 v[198:199], v9 offset:1024
    s_waitcnt lgkmcnt(6)
    v_mfma_f32_32x32x16_bf16 v[160:175], v[216:219], v[60:63], v[160:175]
    ds_read_b64_tr_b16 v[200:201], v9 offset:160
    ds_read_b64_tr_b16 v[202:203], v9 offset:1056
    s_waitcnt lgkmcnt(6)
    v_mfma_f32_32x32x16_bf16 v[176:191], v[220:223], v[60:63], v[176:191]
    ds_read_b64_tr_b16 v[204:205], v9 offset:192
    ds_read_b64_tr_b16 v[206:207], v9 offset:1088
    s_waitcnt lgkmcnt(6)
    v_mfma_f32_32x32x16_bf16 v[128:143], v[192:195], v[64:67], v[128:143]
    ds_read_b64_tr_b16 v[208:209], v9 offset:3680
    ds_read_b64_tr_b16 v[210:211], v9 offset:4576
    s_waitcnt lgkmcnt(6)
    v_mfma_f32_32x32x16_bf16 v[144:159], v[196:199], v[64:67], v[144:159]
    ds_read_b64_tr_b16 v[212:213], v9 offset:3712
    ds_read_b64_tr_b16 v[214:215], v9 offset:4608
    s_waitcnt lgkmcnt(6)
    v_mfma_f32_32x32x16_bf16 v[160:175], v[200:203], v[64:67], v[160:175]
    ds_read_b64_tr_b16 v[216:217], v9 offset:3744
    ds_read_b64_tr_b16 v[218:219], v9 offset:4640
    s_waitcnt lgkmcnt(6)
    v_mfma_f32_32x32x16_bf16 v[176:191], v[204:207], v[64:67], v[176:191]
    s_mov_b64 exec, s[54:55]
    s_mov_b32 s50, 1490944
    s_add_u32 m0, s60, 114688
    s_nop 0
    buffer_load_dwordx4 v6, s[32:35], s50 offen lds
    s_add_u32 m0, s60, 121984
    s_nop 0
    buffer_load_dwordx4 v6, s[36:39], s50 offen lds
    s_mov_b64 exec, -1
    ds_read_b64_tr_b16 v[220:221], v9 offset:3776
    ds_read_b64_tr_b16 v[222:223], v9 offset:4672
    s_waitcnt lgkmcnt(6)
    v_mfma_f32_32x32x16_bf16 v[128:143], v[208:211], v[68:71], v[128:143]
    v_add_u32 v9, 14848, v8
    ds_read_b64_tr_b16 v[192:193], v9 offset:96
    ds_read_b64_tr_b16 v[194:195], v9 offset:992
    s_waitcnt lgkmcnt(6)
    v_mfma_f32_32x32x16_bf16 v[144:159], v[212:215], v[68:71], v[144:159]
    ds_read_b64_tr_b16 v[196:197], v9 offset:128
    ds_read_b64_tr_b16 v[198:199], v9 offset:1024
    s_waitcnt lgkmcnt(6)
    v_mfma_f32_32x32x16_bf16 v[160:175], v[216:219], v[68:71], v[160:175]
    ds_read_b64_tr_b16 v[200:201], v9 offset:160
    ds_read_b64_tr_b16 v[202:203], v9 offset:1056
    s_waitcnt lgkmcnt(6)
    v_mfma_f32_32x32x16_bf16 v[176:191], v[220:223], v[68:71], v[176:191]
    ds_read_b64_tr_b16 v[204:205], v9 offset:192
    ds_read_b64_tr_b16 v[206:207], v9 offset:1088
    s_waitcnt lgkmcnt(6)
    v_mfma_f32_32x32x16_bf16 v[128:143], v[192:195], v[72:75], v[128:143]
    ds_read_b64_tr_b16 v[208:209], v9 offset:3680
    ds_read_b64_tr_b16 v[210:211], v9 offset:4576
    s_waitcnt lgkmcnt(6)
    v_mfma_f32_32x32x16_bf16 v[144:159], v[196:199], v[72:75], v[144:159]
    ds_read_b64_tr_b16 v[212:213], v9 offset:3712
    ds_read_b64_tr_b16 v[214:215], v9 offset:4608
    s_waitcnt lgkmcnt(6)
    v_mfma_f32_32x32x16_bf16 v[160:175], v[200:203], v[72:75], v[160:175]
    ds_read_b64_tr_b16 v[216:217], v9 offset:3744
    ds_read_b64_tr_b16 v[218:219], v9 offset:4640
    s_waitcnt lgkmcnt(6)
    v_mfma_f32_32x32x16_bf16 v[176:191], v[204:207], v[72:75], v[176:191]
    ds_read_b64_tr_b16 v[220:221], v9 offset:3776
    ds_read_b64_tr_b16 v[222:223], v9 offset:4672
    s_waitcnt lgkmcnt(6)
    v_mfma_f32_32x32x16_bf16 v[128:143], v[208:211], v[76:79], v[128:143]
    s_waitcnt vmcnt(8)
    s_barrier
    v_add_u32 v9, 29696, v8
    ds_read_b64_tr_b16 v[192:193], v9 offset:96
    ds_read_b64_tr_b16 v[194:195], v9 offset:992
    s_waitcnt lgkmcnt(6)
    v_mfma_f32_32x32x16_bf16 v[144:159], v[212:215], v[76:79], v[144:159]
    ds_read_b64_tr_b16 v[196:197], v9 offset:128
    ds_read_b64_tr_b16 v[198:199], v9 offset:1024
    s_waitcnt lgkmcnt(6)
    v_mfma_f32_32x32x16_bf16 v[160:175], v[216:219], v[76:79], v[160:175]
    ds_read_b64_tr_b16 v[200:201], v9 offset:160
    ds_read_b64_tr_b16 v[202:203], v9 offset:1056
    s_waitcnt lgkmcnt(6)
    v_mfma_f32_32x32x16_bf16 v[176:191], v[220:223], v[76:79], v[176:191]
    ds_read_b64_tr_b16 v[204:205], v9 offset:192
    ds_read_b64_tr_b16 v[206:207], v9 offset:1088
    s_waitcnt lgkmcnt(6)
    v_mfma_f32_32x32x16_bf16 v[128:143], v[192:195], v[80:83], v[128:143]
    ds_read_b64_tr_b16 v[208:209], v9 offset:3680
    ds_read_b64_tr_b16 v[210:211], v9 offset:4576
    s_waitcnt lgkmcnt(6)
    v_mfma_f32_32x32x16_bf16 v[144:159], v[196:199], v[80:83], v[144:159]
    ds_read_b64_tr_b16 v[212:213], v9 offset:3712
    ds_read_b64_tr_b16 v[214:215], v9 offset:4608
    s_waitcnt lgkmcnt(6)
    v_mfma_f32_32x32x16_bf16 v[160:175], v[200:203], v[80:83], v[160:175]
    ds_read_b64_tr_b16 v[216:217], v9 offset:3744
    ds_read_b64_tr_b16 v[218:219], v9 offset:4640
    s_waitcnt lgkmcnt(6)
    v_mfma_f32_32x32x16_bf16 v[176:191], v[204:207], v[80:83], v[176:191]
    ds_read_b64_tr_b16 v[220:221], v9 offset:3776
    ds_read_b64_tr_b16 v[222:223], v9 offset:4672
    s_waitcnt lgkmcnt(6)
    v_mfma_f32_32x32x16_bf16 v[128:143], v[208:211], v[84:87], v[128:143]
    v_lshlrev_b32 v243, 4, v1
    v_bfe_u32 v12, v1, 4, 1
    v_lshlrev_b32 v12, 7, v12
    v_xor_b32 v241, v243, v12
    v_add_u32 v9, 44544, v8
    ds_read_b64_tr_b16 v[192:193], v9 offset:96
    ds_read_b64_tr_b16 v[194:195], v9 offset:992
    s_waitcnt lgkmcnt(6)
    v_mfma_f32_32x32x16_bf16 v[144:159], v[212:215], v[84:87], v[144:159]
    ds_read_b64_tr_b16 v[196:197], v9 offset:128
    ds_read_b64_tr_b16 v[198:199], v9 offset:1024
    s_waitcnt lgkmcnt(6)
    v_mfma_f32_32x32x16_bf16 v[160:175], v[216:219], v[84:87], v[160:175]
    ds_read_b64_tr_b16 v[200:201], v9 offset:160
    ds_read_b64_tr_b16 v[202:203], v9 offset:1056
    s_waitcnt lgkmcnt(6)
    v_mfma_f32_32x32x16_bf16 v[176:191], v[220:223], v[84:87], v[176:191]
    ds_read_b64_tr_b16 v[204:205], v9 offset:192
    ds_read_b64_tr_b16 v[206:207], v9 offset:1088
    s_waitcnt lgkmcnt(6)
    v_mfma_f32_32x32x16_bf16 v[128:143], v[192:195], v[88:91], v[128:143]
    ds_read_b64_tr_b16 v[208:209], v9 offset:3680
    ds_read_b64_tr_b16 v[210:211], v9 offset:4576
    s_waitcnt lgkmcnt(6)
    v_mfma_f32_32x32x16_bf16 v[144:159], v[196:199], v[88:91], v[144:159]
    ds_read_b64_tr_b16 v[212:213], v9 offset:3712
    ds_read_b64_tr_b16 v[214:215], v9 offset:4608
    s_waitcnt lgkmcnt(6)
    v_mfma_f32_32x32x16_bf16 v[160:175], v[200:203], v[88:91], v[160:175]
    ds_read_b64_tr_b16 v[216:217], v9 offset:3744
    ds_read_b64_tr_b16 v[218:219], v9 offset:4640
    s_waitcnt lgkmcnt(6)
    v_mfma_f32_32x32x16_bf16 v[176:191], v[204:207], v[88:91], v[176:191]
    ds_read_b64_tr_b16 v[220:221], v9 offset:3776
    ds_read_b64_tr_b16 v[222:223], v9 offset:4672
    s_waitcnt lgkmcnt(6)
    v_mfma_f32_32x32x16_bf16 v[128:143], v[208:211], v[92:95], v[128:143]
    s_cmp_lg_u32 s46, 0
    s_cbranch_scc1 L_kvc_12
    s_waitcnt vmcnt(2)
    s_mov_b64 exec, 0x7f
    v_cmp_ne_u64 vcc, s[90:91], v[252:253]
    s_mov_b64 exec, -1
    s_cmp_eq_u64 vcc, 0
    s_cbranch_scc1 L_kvc_12
    s_mov_b32 s95, 0
    s_mov_b64 exec, 127
L_poll_13:
    buffer_load_dwordx2 v[252:253], v255, s[96:99], 0 offen sc1
    s_waitcnt vmcnt(0)
    v_cmp_ne_u64 vcc, s[90:91], v[252:253]
    s_nop 1
    s_cmp_eq_u64 vcc, 0
    s_cbranch_scc1 L_polld_14
    s_sleep 2
    s_add_u32 s95, s95, 1
    s_cmp_lt_u32 s95, 0x40000
    s_cbranch_scc1 L_poll_13
L_polld_14:
    s_mov_b64 exec, -1
L_kvc_12:
    s_waitcnt vmcnt(4)
    s_barrier
    s_lshl_b32 s49, s44, 17
    s_lshl_b32 s50, s45, 3
    s_mul_i32 s51, s46, 3
    s_add_u32 s50, s50, s51
    s_mul_i32 s51, s46, 3072
    s_add_i32 s61, s50, -16
    s_max_i32 s61, s61, 0
    s_lshl_b32 s61, s61, 10
    s_add_u32 s61, s61, s49
    s_add_u32 s92, s61, 2097152
    s_add_u32 m0, s51, 129536
    s_nop 0
    buffer_load_dwordx4 v243, s[40:43], s92 offen sc1 lds
    s_add_u32 s92, s61, 4194304
    s_add_u32 m0, s51, 0
    s_nop 0
    buffer_load_dwordx4 v241, s[40:43], s92 offen sc1 lds
    s_add_i32 s61, s50, -15
    s_max_i32 s61, s61, 0
    s_lshl_b32 s61, s61, 10
    s_add_u32 s61, s61, s49
    s_add_u32 s92, s61, 2097152
    s_add_u32 m0, s51, 130560
    s_nop 0
    buffer_load_dwordx4 v243, s[40:43], s92 offen sc1 lds
    s_add_u32 s92, s61, 4194304
    s_add_u32 m0, s51, 1024
    s_nop 0
    buffer_load_dwordx4 v241, s[40:43], s92 offen sc1 lds
    s_add_i32 s61, s50, -14
    s_max_i32 s61, s61, 0
    s_lshl_b32 s61, s61, 10
    s_add_u32 s61, s61, s49
    s_add_u32 s92, s61, 2097152
    s_add_u32 m0, s51, 131584
    s_nop 0
    buffer_load_dwordx4 v243, s[40:43], s92 offen sc1 lds
    s_add_u32 s92, s61, 4194304
    s_add_u32 m0, s51, 2048
    s_nop 0
    buffer_load_dwordx4 v241, s[40:43], s92 offen sc1 lds
    s_lshl_b32 s50, s45, 3
    s_add_u32 s50, s50, s46
    s_lshl_b32 s61, s50, 10
    s_add_u32 s61, s61, s49
    buffer_load_dwordx4 v[244:247], v243, s[40:43], s61 offen sc1
    v_add_u32 v9, 59392, v8
    ds_read_b64_tr_b16 v[192:193], v9 offset:96
    ds_read_b64_tr_b16 v[194:195], v9 offset:992
    s_waitcnt lgkmcnt(6)
    v_mfma_f32_32x32x16_bf16 v[144:159], v[212:215], v[92:95], v[144:159]
    ds_read_b64_tr_b16 v[196:197], v9 offset:128
    ds_read_b64_tr_b16 v[198:199], v9 offset:1024
    s_waitcnt lgkmcnt(6)
    v_mfma_f32_32x32x16_bf16 v[160:175], v[216:219], v[92:95], v[160:175]
    ds_read_b64_tr_b16 v[200:201], v9 offset:160
    ds_read_b64_tr_b16 v[202:203], v9 offset:1056
    s_waitcnt lgkmcnt(6)
    v_mfma_f32_32x32x16_bf16 v[176:191], v[220:223], v[92:95], v[176:191]
    ds_read_b64_tr_b16 v[204:205], v9 offset:192
    ds_read_b64_tr_b16 v[206:207], v9 offset:1088
    s_waitcnt lgkmcnt(6)
    v_mfma_f32_32x32x16_bf16 v[128:143], v[192:195], v[96:99], v[128:143]
    ds_read_b64_tr_b16 v[208:209], v9 offset:3680
    ds_read_b64_tr_b16 v[210:211], v9 offset:4576
    s_waitcnt lgkmcnt(6)
    v_mfma_f32_32x32x16_bf16 v[144:159], v[196:199], v[96:99], v[144:159]
    ds_read_b64_tr_b16 v[212:213], v9 offset:3712
    ds_read_b64_tr_b16 v[214:215], v9 offset:4608
    s_waitcnt lgkmcnt(6)
    v_mfma_f32_32x32x16_bf16 v[160:175], v[200:203], v[96:99], v[160:175]
    ds_read_b64_tr_b16 v[216:217], v9 offset:3744
    ds_read_b64_tr_b16 v[218:219], v9 offset:4640
    s_waitcnt lgkmcnt(6)
    v_mfma_f32_32x32x16_bf16 v[176:191], v[204:207], v[96:99], v[176:191]
    ds_read_b64_tr_b16 v[220:221], v9 offset:3776
    ds_read_b64_tr_b16 v[222:223], v9 offset:4672
    s_waitcnt lgkmcnt(6)
    v_mfma_f32_32x32x16_bf16 v[128:143], v[208:211], v[100:103], v[128:143]
    v_add_u32 v9, 74240, v8
    ds_read_b64_tr_b16 v[192:193], v9 offset:96
    ds_read_b64_tr_b16 v[194:195], v9 offset:992
    s_waitcnt lgkmcnt(6)
    v_mfma_f32_32x32x16_bf16 v[144:159], v[212:215], v[100:103], v[144:159]
    ds_read_b64_tr_b16 v[196:197], v9 offset:128
    ds_read_b64_tr_b16 v[198:199], v9 offset:1024
    s_waitcnt lgkmcnt(6)
    v_mfma_f32_32x32x16_bf16 v[160:175], v[216:219], v[100:103], v[160:175]
    ds_read_b64_tr_b16 v[200:201], v9 offset:160
    ds_read_b64_tr_b16 v[202:203], v9 offset:1056
    s_waitcnt lgkmcnt(6)
    v_mfma_f32_32x32x16_bf16 v[176:191], v[220:223], v[100:103], v[176:191]
    ds_read_b64_tr_b16 v[204:205], v9 offset:192
    ds_read_b64_tr_b16 v[206:207], v9 offset:1088
    s_waitcnt lgkmcnt(6)
    v_mfma_f32_32x32x16_bf16 v[128:143], v[192:195], v[104:107], v[128:143]
    ds_read_b64_tr_b16 v[208:209], v9 offset:3680
    ds_read_b64_tr_b16 v[210:211], v9 offset:4576
    s_waitcnt lgkmcnt(6)
    v_mfma_f32_32x32x16_bf16 v[144:159], v[196:199], v[104:107], v[144:159]
    ds_read_b64_tr_b16 v[212:213], v9 offset:3712
    ds_read_b64_tr_b16 v[214:215], v9 offset:4608
    s_waitcnt lgkmcnt(6)
    v_mfma_f32_32x32x16_bf16 v[160:175], v[200:203], v[104:107], v[160:175]
    ds_read_b64_tr_b16 v[216:217], v9 offset:3744
    ds_read_b64_tr_b16 v[218:219], v9 offset:4640
    s_waitcnt lgkmcnt(6)
    v_mfma_f32_32x32x16_bf16 v[176:191], v[204:207], v[104:107], v[176:191]
    ds_read_b64_tr_b16 v[220:221], v9 offset:3776
    ds_read_b64_tr_b16 v[222:223], v9 offset:4672
    s_waitcnt lgkmcnt(6)
    v_mfma_f32_32x32x16_bf16 v[128:143], v[208:211], v[108:111], v[128:143]
    s_waitcnt vmcnt(7)
    s_barrier
    v_add_u32 v9, 89088, v8
    ds_read_b64_tr_b16 v[192:193], v9 offset:96
    ds_read_b64_tr_b16 v[194:195], v9 offset:992
    s_waitcnt lgkmcnt(6)
    v_mfma_f32_32x32x16_bf16 v[144:159], v[212:215], v[108:111], v[144:159]
    ds_read_b64_tr_b16 v[196:197], v9 offset:128
    ds_read_b64_tr_b16 v[198:199], v9 offset:1024
    s_waitcnt lgkmcnt(6)
    v_mfma_f32_32x32x16_bf16 v[160:175], v[216:219], v[108:111], v[160:175]
    ds_read_b64_tr_b16 v[200:201], v9 offset:160
    ds_read_b64_tr_b16 v[202:203], v9 offset:1056
    s_waitcnt lgkmcnt(6)
    v_mfma_f32_32x32x16_bf16 v[176:191], v[220:223], v[108:111], v[176:191]
    ds_read_b64_tr_b16 v[204:205], v9 offset:192
    ds_read_b64_tr_b16 v[206:207], v9 offset:1088
    s_waitcnt lgkmcnt(6)
    v_mfma_f32_32x32x16_bf16 v[128:143], v[192:195], v[112:115], v[128:143]
    ds_read_b64_tr_b16 v[208:209], v9 offset:3680
    ds_read_b64_tr_b16 v[210:211], v9 offset:4576
    s_waitcnt lgkmcnt(6)
    v_mfma_f32_32x32x16_bf16 v[144:159], v[196:199], v[112:115], v[144:159]
    ds_read_b64_tr_b16 v[212:213], v9 offset:3712
    ds_read_b64_tr_b16 v[214:215], v9 offset:4608
    s_waitcnt lgkmcnt(6)
    v_mfma_f32_32x32x16_bf16 v[160:175], v[200:203], v[112:115], v[160:175]
    ds_read_b64_tr_b16 v[216:217], v9 offset:3744
    ds_read_b64_tr_b16 v[218:219], v9 offset:4640
    s_waitcnt lgkmcnt(6)
    v_mfma_f32_32x32x16_bf16 v[176:191], v[204:207], v[112:115], v[176:191]
    ds_read_b64_tr_b16 v[220:221], v9 offset:3776
    ds_read_b64_tr_b16 v[222:223], v9 offset:4672
    s_waitcnt lgkmcnt(6)
    v_mfma_f32_32x32x16_bf16 v[128:143], v[208:211], v[116:119], v[128:143]
    v_add_u32 v9, 114688, v8
    ds_read_b64_tr_b16 v[192:193], v9 offset:96
    ds_read_b64_tr_b16 v[194:195], v9 offset:992
    s_waitcnt lgkmcnt(6)
    v_mfma_f32_32x32x16_bf16 v[144:159], v[212:215], v[116:119], v[144:159]
    ds_read_b64_tr_b16 v[196:197], v9 offset:128
    ds_read_b64_tr_b16 v[198:199], v9 offset:1024
    s_waitcnt lgkmcnt(6)
    v_mfma_f32_32x32x16_bf16 v[160:175], v[216:219], v[116:119], v[160:175]
    ds_read_b64_tr_b16 v[200:201], v9 offset:160
    ds_read_b64_tr_b16 v[202:203], v9 offset:1056
    s_waitcnt lgkmcnt(6)
    v_mfma_f32_32x32x16_bf16 v[176:191], v[220:223], v[116:119], v[176:191]
    ds_read_b64_tr_b16 v[204:205], v9 offset:192
    ds_read_b64_tr_b16 v[206:207], v9 offset:1088
    s_waitcnt lgkmcnt(6)
    v_mfma_f32_32x32x16_bf16 v[128:143], v[192:195], v[120:123], v[128:143]
    ds_read_b64_tr_b16 v[208:209], v9 offset:3680
    ds_read_b64_tr_b16 v[210:211], v9 offset:4576
    s_waitcnt lgkmcnt(6)
    v_mfma_f32_32x32x16_bf16 v[144:159], v[196:199], v[120:123], v[144:159]
    ds_read_b64_tr_b16 v[212:213], v9 offset:3712
    ds_read_b64_tr_b16 v[214:215], v9 offset:4608
    s_waitcnt lgkmcnt(6)
    v_mfma_f32_32x32x16_bf16 v[160:175], v[200:203], v[120:123], v[160:175]
    ds_read_b64_tr_b16 v[216:217], v9 offset:3744
    ds_read_b64_tr_b16 v[218:219], v9 offset:4640
    s_waitcnt lgkmcnt(6)
    v_mfma_f32_32x32x16_bf16 v[176:191], v[204:207], v[120:123], v[176:191]
    ds_read_b64_tr_b16 v[220:221], v9 offset:3776
    ds_read_b64_tr_b16 v[222:223], v9 offset:4672
    s_waitcnt lgkmcnt(6)
    v_mfma_f32_32x32x16_bf16 v[128:143], v[208:211], v[124:127], v[128:143]
    s_waitcnt lgkmcnt(4)
    v_mfma_f32_32x32x16_bf16 v[144:159], v[212:215], v[124:127], v[144:159]
    s_waitcnt lgkmcnt(2)
    v_mfma_f32_32x32x16_bf16 v[160:175], v[216:219], v[124:127], v[160:175]
    s_waitcnt lgkmcnt(0)
    v_mfma_f32_32x32x16_bf16 v[176:191], v[220:223], v[124:127], v[176:191]
    v_mov_b32 v15, s58
    s_nop 4
    v_cvt_pk_bf16_f32 v224, v128, v129
    v_cvt_pk_bf16_f32 v228, v136, v137
    v_cvt_pk_bf16_f32 v225, v130, v131
    v_cvt_pk_bf16_f32 v229, v138, v139
    v_cvt_pk_bf16_f32 v226, v132, v133
    v_cvt_pk_bf16_f32 v230, v140, v141
    v_cvt_pk_bf16_f32 v227, v134, v135
    v_cvt_pk_bf16_f32 v231, v142, v143
    v_lshlrev_b32 v128, 16, v224
    v_and_b32 v129, v15, v224
    v_lshlrev_b32 v130, 16, v228
    v_and_b32 v131, v15, v228
    v_lshlrev_b32 v132, 16, v225
    v_and_b32 v133, v15, v225
    v_lshlrev_b32 v134, 16, v229
    v_and_b32 v135, v15, v229
    v_lshlrev_b32 v136, 16, v226
    v_and_b32 v137, v15, v226
    v_lshlrev_b32 v138, 16, v230
    v_and_b32 v139, v15, v230
    v_lshlrev_b32 v140, 16, v227
    v_and_b32 v141, v15, v227
    v_lshlrev_b32 v142, 16, v231
    v_and_b32 v143, v15, v231
    v_mul_f32 v128, v128, v130
    v_mul_f32 v129, v129, v131
    v_mul_f32 v132, v132, v134
    v_mul_f32 v133, v133, v135
    v_mul_f32 v136, v136, v138
    v_mul_f32 v137, v137, v139
    v_mul_f32 v140, v140, v142
    v_mul_f32 v141, v141, v143
    v_cvt_pk_bf16_f32 v192, v128, v129
    v_cvt_pk_bf16_f32 v193, v132, v133
    v_cvt_pk_bf16_f32 v194, v136, v137
    v_cvt_pk_bf16_f32 v195, v140, v141
    s_mov_b32 s50, 3072
    buffer_store_dwordx4 v[192:195], v242, s[40:43], s50 offen sc1
    v_cvt_pk_bf16_f32 v224, v144, v145
    v_cvt_pk_bf16_f32 v228, v152, v153
    v_cvt_pk_bf16_f32 v225, v146, v147
    v_cvt_pk_bf16_f32 v229, v154, v155
    v_cvt_pk_bf16_f32 v226, v148, v149
    v_cvt_pk_bf16_f32 v230, v156, v157
    v_cvt_pk_bf16_f32 v227, v150, v151
    v_cvt_pk_bf16_f32 v231, v158, v159
    v_lshlrev_b32 v144, 16, v224
    v_and_b32 v145, v15, v224
    v_lshlrev_b32 v146, 16, v228
    v_and_b32 v147, v15, v228
    v_lshlrev_b32 v148, 16, v225
    v_and_b32 v149, v15, v225
    v_lshlrev_b32 v150, 16, v229
    v_and_b32 v151, v15, v229
    v_lshlrev_b32 v152, 16, v226
    v_and_b32 v153, v15, v226
    v_lshlrev_b32 v154, 16, v230
    v_and_b32 v155, v15, v230
    v_lshlrev_b32 v156, 16, v227
    v_and_b32 v157, v15, v227
    v_lshlrev_b32 v158, 16, v231
    v_and_b32 v159, v15, v231
    v_mul_f32 v144, v144, v146
    v_mul_f32 v145, v145, v147
    v_mul_f32 v148, v148, v150
    v_mul_f32 v149, v149, v151
    v_mul_f32 v152, v152, v154
    v_mul_f32 v153, v153, v155
    v_mul_f32 v156, v156, v158
    v_mul_f32 v157, v157, v159
    v_cvt_pk_bf16_f32 v196, v144, v145
    v_cvt_pk_bf16_f32 v197, v148, v149
    v_cvt_pk_bf16_f32 v198, v152, v153
    v_cvt_pk_bf16_f32 v199, v156, v157
    s_mov_b32 s50, 4096
    buffer_store_dwordx4 v[196:199], v242, s[40:43], s50 offen sc1
    v_cvt_pk_bf16_f32 v224, v160, v161
    v_cvt_pk_bf16_f32 v228, v168, v169
    v_cvt_pk_bf16_f32 v225, v162, v163
    v_cvt_pk_bf16_f32 v229, v170, v171
    v_cvt_pk_bf16_f32 v226, v164, v165
    v_cvt_pk_bf16_f32 v230, v172, v173
    v_cvt_pk_bf16_f32 v227, v166, v167
    v_cvt_pk_bf16_f32 v231, v174, v175
    v_lshlrev_b32 v160, 16, v224
    v_and_b32 v161, v15, v224
    v_lshlrev_b32 v162, 16, v228
    v_and_b32 v163, v15, v228
    v_lshlrev_b32 v164, 16, v225
    v_and_b32 v165, v15, v225
    v_lshlrev_b32 v166, 16, v229
    v_and_b32 v167, v15, v229
    v_lshlrev_b32 v168, 16, v226
    v_and_b32 v169, v15, v226
    v_lshlrev_b32 v170, 16, v230
    v_and_b32 v171, v15, v230
    v_lshlrev_b32 v172, 16, v227
    v_and_b32 v173, v15, v227
    v_lshlrev_b32 v174, 16, v231
    v_and_b32 v175, v15, v231
    v_mul_f32 v160, v160, v162
    v_mul_f32 v161, v161, v163
    v_mul_f32 v164, v164, v166
    v_mul_f32 v165, v165, v167
    v_mul_f32 v168, v168, v170
    v_mul_f32 v169, v169, v171
    v_mul_f32 v172, v172, v174
    v_mul_f32 v173, v173, v175
    v_cvt_pk_bf16_f32 v200, v160, v161
    v_cvt_pk_bf16_f32 v201, v164, v165
    v_cvt_pk_bf16_f32 v202, v168, v169
    v_cvt_pk_bf16_f32 v203, v172, v173
    s_mov_b32 s50, 5120
    buffer_store_dwordx4 v[200:203], v242, s[40:43], s50 offen sc1
    v_cvt_pk_bf16_f32 v224, v176, v177
    v_cvt_pk_bf16_f32 v228, v184, v185
    v_cvt_pk_bf16_f32 v225, v178, v179
    v_cvt_pk_bf16_f32 v229, v186, v187
    v_cvt_pk_bf16_f32 v226, v180, v181
    v_cvt_pk_bf16_f32 v230, v188, v189
    v_cvt_pk_bf16_f32 v227, v182, v183
    v_cvt_pk_bf16_f32 v231, v190, v191
    v_lshlrev_b32 v176, 16, v224
    v_and_b32 v177, v15, v224
    v_lshlrev_b32 v178, 16, v228
    v_and_b32 v179, v15, v228
    v_lshlrev_b32 v180, 16, v225
    v_and_b32 v181, v15, v225
    v_lshlrev_b32 v182, 16, v229
    v_and_b32 v183, v15, v229
    v_lshlrev_b32 v184, 16, v226
    v_and_b32 v185, v15, v226
    v_lshlrev_b32 v186, 16, v230
    v_and_b32 v187, v15, v230
    v_lshlrev_b32 v188, 16, v227
    v_and_b32 v189, v15, v227
    v_lshlrev_b32 v190, 16, v231
    v_and_b32 v191, v15, v231
    v_mul_f32 v176, v176, v178
    v_mul_f32 v177, v177, v179
    v_mul_f32 v180, v180, v182
    v_mul_f32 v181, v181, v183
    v_mul_f32 v184, v184, v186
    v_mul_f32 v185, v185, v187
    v_mul_f32 v188, v188, v190
    v_mul_f32 v189, v189, v191
    v_cvt_pk_bf16_f32 v204, v176, v177
    v_cvt_pk_bf16_f32 v205, v180, v181
    v_cvt_pk_bf16_f32 v206, v184, v185
    v_cvt_pk_bf16_f32 v207, v188, v189
    s_mov_b32 s50, 6144
    buffer_store_dwordx4 v[204:207], v242, s[40:43], s50 offen sc1
L_s1_join:
    v_and_b32 v3, 15, v1
    v_lshrrev_b32 v4, 4, v1
    s_and_b32 s52, s46, 1
    s_lshl_b32 s52, s52, 4
    s_add_u32 s52, s52, 256
    v_add_u32 v5, s52, v3
    v_lshlrev_b32 v6, 2, v4
    v_sub_u32 v5, v5, v6
    s_mov_b32 s56, 0xf149f2ca
    v_mov_b32 v7, s56
    v_mov_b32 v200, s56
    v_mov_b32 v201, s56
    v_mov_b32 v202, s56
    v_mov_b32 v203, s56
    s_movk_i32 s57, 256
    v_subrev_u32 v6, 0, v5
    v_cmp_gt_u32 vcc, s57, v6
    s_nop 1
    v_cndmask_b32 v184, v7, 0, vcc
    v_subrev_u32 v6, 1, v5
    v_cmp_gt_u32 vcc, s57, v6
    s_nop 1
    v_cndmask_b32 v185, v7, 0, vcc
    v_subrev_u32 v6, 2, v5
    v_cmp_gt_u32 vcc, s57, v6
    s_nop 1
    v_cndmask_b32 v186, v7, 0, vcc
    v_subrev_u32 v6, 3, v5
    v_cmp_gt_u32 vcc, s57, v6
    s_nop 1
    v_cndmask_b32 v187, v7, 0, vcc
    v_subrev_u32 v6, 16, v5
    v_cmp_gt_u32 vcc, s57, v6
    s_nop 1
    v_cndmask_b32 v188, v7, 0, vcc
    v_subrev_u32 v6, 17, v5
    v_cmp_gt_u32 vcc, s57, v6
    s_nop 1
    v_cndmask_b32 v189, v7, 0, vcc
    v_subrev_u32 v6, 18, v5
    v_cmp_gt_u32 vcc, s57, v6
    s_nop 1
    v_cndmask_b32 v190, v7, 0, vcc
    v_subrev_u32 v6, 19, v5
    v_cmp_gt_u32 vcc, s57, v6
    s_nop 1
    v_cndmask_b32 v191, v7, 0, vcc
    v_subrev_u32 v6, 256, v5
    v_cmp_gt_u32 vcc, s57, v6
    s_nop 1
    v_cndmask_b32 v192, v7, 0, vcc
    v_subrev_u32 v6, 257, v5
    v_cmp_gt_u32 vcc, s57, v6
    s_nop 1
    v_cndmask_b32 v193, v7, 0, vcc
    v_subrev_u32 v6, 258, v5
    v_cmp_gt_u32 vcc, s57, v6
    s_nop 1
    v_cndmask_b32 v194, v7, 0, vcc
    v_subrev_u32 v6, 259, v5
    v_cmp_gt_u32 vcc, s57, v6
    s_nop 1
    v_cndmask_b32 v195, v7, 0, vcc
    v_subrev_u32 v6, 272, v5
    v_cmp_gt_u32 vcc, s57, v6
    s_nop 1
    v_cndmask_b32 v196, v7, 0, vcc
    v_subrev_u32 v6, 273, v5
    v_cmp_gt_u32 vcc, s57, v6
    s_nop 1
    v_cndmask_b32 v197, v7, 0, vcc
    v_subrev_u32 v6, 274, v5
    v_cmp_gt_u32 vcc, s57, v6
    s_nop 1
    v_cndmask_b32 v198, v7, 0, vcc
    v_subrev_u32 v6, 275, v5
    v_cmp_gt_u32 vcc, s57, v6
    s_nop 1
    v_cndmask_b32 v199, v7, 0, vcc
    s_lshl_b32 s52, s45, 3
    s_sub_i32 s58, 16, s52
    s_and_b32 s52, s46, 6
    s_sub_i32 s58, s58, s52
    s_lshr_b32 s52, s46, 1
    s_lshl_b32 s52, s52, 11
    v_lshlrev_b32 v2, 4, v1
    v_add_u32 v8, s52, v2
    v_add_u32 v8, 129536, v8
    v_and_b32 v12, 15, v1
    v_lshrrev_b32 v13, 2, v12
    v_lshl_add_u32 v13, v4, 2, v13
    v_bfe_u32 v14, v1, 1, 1
    v_lshlrev_b32 v15, 3, v14
    v_xor_b32 v13, v13, v15
    v_lshlrev_b32 v9, 4, v13
    v_lshl_add_u32 v9, v14, 8, v9
    v_and_b32 v14, 1, v1
    v_lshl_add_u32 v9, v14, 3, v9
    v_add_u32 v9, s52, v9
    s_lshl_b32 s50, s45, 3
    s_add_u32 s50, s50, s46
    s_lshl_b32 s52, s50, 4
    s_add_u32 s52, s52, s44
    s_lshl_b32 s52, s52, 10
    s_add_u32 s55, s52, 14680064
    s_waitcnt vmcnt(4)
    s_barrier
    s_cmp_gt_i32 s58, 0
    s_cbranch_scc1 L_a_slow
    ds_read_b128 v[144:147], v8 offset:0
    ds_read_b128 v[148:151], v8 offset:1024
    ds_read_b128 v[152:155], v8 offset:2048
    ds_read_b128 v[156:159], v8 offset:3072
    s_waitcnt lgkmcnt(3)
    v_mfma_f32_16x16x32_bf16 v[32:35], v[144:147], v[244:247], v[184:187]
    ds_read_b128 v[144:147], v8 offset:4096
    s_waitcnt lgkmcnt(3)
    v_mfma_f32_16x16x32_bf16 v[36:39], v[148:151], v[244:247], v[188:191]
    ds_read_b128 v[148:151], v8 offset:5120
    s_waitcnt lgkmcnt(3)
    v_mfma_f32_16x16x32_bf16 v[40:43], v[152:155], v[244:247], 0
    ds_read_b128 v[152:155], v8 offset:6144
    s_waitcnt lgkmcnt(3)
    v_mfma_f32_16x16x32_bf16 v[44:47], v[156:159], v[244:247], 0
    ds_read_b128 v[156:159], v8 offset:7168
    s_waitcnt lgkmcnt(3)
    v_mfma_f32_16x16x32_bf16 v[48:51], v[144:147], v[244:247], 0
    ds_read_b128 v[144:147], v8 offset:8192
    s_waitcnt lgkmcnt(3)
    v_mfma_f32_16x16x32_bf16 v[52:55], v[148:151], v[244:247], 0
    ds_read_b128 v[148:151], v8 offset:9216
    s_waitcnt lgkmcnt(3)
    v_mfma_f32_16x16x32_bf16 v[56:59], v[152:155], v[244:247], 0
    ds_read_b128 v[152:155], v8 offset:10240
    s_waitcnt lgkmcnt(3)
    v_mfma_f32_16x16x32_bf16 v[60:63], v[156:159], v[244:247], 0
    ds_read_b128 v[156:159], v8 offset:11264
    s_waitcnt lgkmcnt(3)
    v_mfma_f32_16x16x32_bf16 v[64:67], v[144:147], v[244:247], 0
    ds_read_b128 v[144:147], v8 offset:12288
    s_waitcnt lgkmcnt(3)
    v_mfma_f32_16x16x32_bf16 v[68:71], v[148:151], v[244:247], 0
    ds_read_b128 v[148:151], v8 offset:13312
    s_waitcnt lgkmcnt(3)
    v_mfma_f32_16x16x32_bf16 v[72:75], v[152:155], v[244:247], 0
    ds_read_b128 v[152:155], v8 offset:14336
    s_waitcnt lgkmcnt(3)
    v_mfma_f32_16x16x32_bf16 v[76:79], v[156:159], v[244:247], 0
    ds_read_b128 v[156:159], v8 offset:15360
    s_waitcnt lgkmcnt(3)
    v_mfma_f32_16x16x32_bf16 v[80:83], v[144:147], v[244:247], 0
    ds_read_b128 v[144:147], v8 offset:16384
    s_waitcnt lgkmcnt(3)
    v_mfma_f32_16x16x32_bf16 v[84:87], v[148:151], v[244:247], 0
    ds_read_b128 v[148:151], v8 offset:17408
    s_waitcnt lgkmcnt(3)
    v_mfma_f32_16x16x32_bf16 v[88:91], v[152:155], v[244:247], 0
    s_waitcnt lgkmcnt(2)
    v_mfma_f32_16x16x32_bf16 v[92:95], v[156:159], v[244:247], 0
    s_waitcnt lgkmcnt(1)
    v_mfma_f32_16x16x32_bf16 v[96:99], v[144:147], v[244:247], v[192:195]
    s_waitcnt lgkmcnt(0)
    v_mfma_f32_16x16x32_bf16 v[100:103], v[148:151], v[244:247], v[196:199]
    s_branch L_a_join
L_a_slow:
    ds_read_b128 v[144:147], v8 offset:0
    ds_read_b128 v[148:151], v8 offset:1024
    ds_read_b128 v[152:155], v8 offset:2048
    ds_read_b128 v[156:159], v8 offset:3072
    s_waitcnt lgkmcnt(3)
    s_cmp_gt_i32 s58, 0
    s_cbranch_scc1 L_sl_15
    v_mfma_f32_16x16x32_bf16 v[32:35], v[144:147], v[244:247], v[184:187]
    s_branch L_sl_16
L_sl_15:
    s_nop 4
    v_mfma_f32_16x16x32_bf16 v[32:35], v[144:147], v[244:247], v[200:203]
L_sl_16:
    ds_read_b128 v[144:147], v8 offset:4096
    s_waitcnt lgkmcnt(3)
    s_cmp_gt_i32 s58, 1
    s_cbranch_scc1 L_sl_17
    v_mfma_f32_16x16x32_bf16 v[36:39], v[148:151], v[244:247], v[188:191]
    s_branch L_sl_18
L_sl_17:
    s_nop 4
    v_mfma_f32_16x16x32_bf16 v[36:39], v[148:151], v[244:247], v[200:203]
L_sl_18:
    ds_read_b128 v[148:151], v8 offset:5120
    s_waitcnt lgkmcnt(3)
    s_cmp_gt_i32 s58, 2
    s_cbranch_scc1 L_sl_19
    v_mfma_f32_16x16x32_bf16 v[40:43], v[152:155], v[244:247], 0
    s_branch L_sl_20
L_sl_19:
    s_nop 4
    v_mfma_f32_16x16x32_bf16 v[40:43], v[152:155], v[244:247], v[200:203]
L_sl_20:
    ds_read_b128 v[152:155], v8 offset:6144
    s_waitcnt lgkmcnt(3)
    s_cmp_gt_i32 s58, 3
    s_cbranch_scc1 L_sl_21
    v_mfma_f32_16x16x32_bf16 v[44:47], v[156:159], v[244:247], 0
    s_branch L_sl_22
L_sl_21:
    s_nop 4
    v_mfma_f32_16x16x32_bf16 v[44:47], v[156:159], v[244:247], v[200:203]
L_sl_22:
    ds_read_b128 v[156:159], v8 offset:7168
    s_waitcnt lgkmcnt(3)
    s_cmp_gt_i32 s58, 4
    s_cbranch_scc1 L_sl_23
    v_mfma_f32_16x16x32_bf16 v[48:51], v[144:147], v[244:247], 0
    s_branch L_sl_24
L_sl_23:
    s_nop 4
    v_mfma_f32_16x16x32_bf16 v[48:51], v[144:147], v[244:247], v[200:203]
L_sl_24:
    ds_read_b128 v[144:147], v8 offset:8192
    s_waitcnt lgkmcnt(3)
    s_cmp_gt_i32 s58, 5
    s_cbranch_scc1 L_sl_25
    v_mfma_f32_16x16x32_bf16 v[52:55], v[148:151], v[244:247], 0
    s_branch L_sl_26
L_sl_25:
    s_nop 4
    v_mfma_f32_16x16x32_bf16 v[52:55], v[148:151], v[244:247], v[200:203]
L_sl_26:
    ds_read_b128 v[148:151], v8 offset:9216
    s_waitcnt lgkmcnt(3)
    s_cmp_gt_i32 s58, 6
    s_cbranch_scc1 L_sl_27
    v_mfma_f32_16x16x32_bf16 v[56:59], v[152:155], v[244:247], 0
    s_branch L_sl_28
L_sl_27:
    s_nop 4
    v_mfma_f32_16x16x32_bf16 v[56:59], v[152:155], v[244:247], v[200:203]
L_sl_28:
    ds_read_b128 v[152:155], v8 offset:10240
    s_waitcnt lgkmcnt(3)
    s_cmp_gt_i32 s58, 7
    s_cbranch_scc1 L_sl_29
    v_mfma_f32_16x16x32_bf16 v[60:63], v[156:159], v[244:247], 0
    s_branch L_sl_30
L_sl_29:
    s_nop 4
    v_mfma_f32_16x16x32_bf16 v[60:63], v[156:159], v[244:247], v[200:203]
L_sl_30:
    ds_read_b128 v[156:159], v8 offset:11264
    s_waitcnt lgkmcnt(3)
    s_cmp_gt_i32 s58, 8
    s_cbranch_scc1 L_sl_31
    v_mfma_f32_16x16x32_bf16 v[64:67], v[144:147], v[244:247], 0
    s_branch L_sl_32
L_sl_31:
    s_nop 4
    v_mfma_f32_16x16x32_bf16 v[64:67], v[144:147], v[244:247], v[200:203]
L_sl_32:
    ds_read_b128 v[144:147], v8 offset:12288
    s_waitcnt lgkmcnt(3)
    s_cmp_gt_i32 s58, 9
    s_cbranch_scc1 L_sl_33
    v_mfma_f32_16x16x32_bf16 v[68:71], v[148:151], v[244:247], 0
    s_branch L_sl_34
L_sl_33:
    s_nop 4
    v_mfma_f32_16x16x32_bf16 v[68:71], v[148:151], v[244:247], v[200:203]
L_sl_34:
    ds_read_b128 v[148:151], v8 offset:13312
    s_waitcnt lgkmcnt(3)
    s_cmp_gt_i32 s58, 10
    s_cbranch_scc1 L_sl_35
    v_mfma_f32_16x16x32_bf16 v[72:75], v[152:155], v[244:247], 0
    s_branch L_sl_36
L_sl_35:
    s_nop 4
    v_mfma_f32_16x16x32_bf16 v[72:75], v[152:155], v[244:247], v[200:203]
L_sl_36:
    ds_read_b128 v[152:155], v8 offset:14336
    s_waitcnt lgkmcnt(3)
    s_cmp_gt_i32 s58, 11
    s_cbranch_scc1 L_sl_37
    v_mfma_f32_16x16x32_bf16 v[76:79], v[156:159], v[244:247], 0
    s_branch L_sl_38
L_sl_37:
    s_nop 4
    v_mfma_f32_16x16x32_bf16 v[76:79], v[156:159], v[244:247], v[200:203]
L_sl_38:
    ds_read_b128 v[156:159], v8 offset:15360
    s_waitcnt lgkmcnt(3)
    s_cmp_gt_i32 s58, 12
    s_cbranch_scc1 L_sl_39
    v_mfma_f32_16x16x32_bf16 v[80:83], v[144:147], v[244:247], 0
    s_branch L_sl_40
L_sl_39:
    s_nop 4
    v_mfma_f32_16x16x32_bf16 v[80:83], v[144:147], v[244:247], v[200:203]
L_sl_40:
    ds_read_b128 v[144:147], v8 offset:16384
    s_waitcnt lgkmcnt(3)
    s_cmp_gt_i32 s58, 13
    s_cbranch_scc1 L_sl_41
    v_mfma_f32_16x16x32_bf16 v[84:87], v[148:151], v[244:247], 0
    s_branch L_sl_42
L_sl_41:
    s_nop 4
    v_mfma_f32_16x16x32_bf16 v[84:87], v[148:151], v[244:247], v[200:203]
L_sl_42:
    ds_read_b128 v[148:151], v8 offset:17408
    s_waitcnt lgkmcnt(3)
    s_cmp_gt_i32 s58, 14
    s_cbranch_scc1 L_sl_43
    v_mfma_f32_16x16x32_bf16 v[88:91], v[152:155], v[244:247], 0
    s_branch L_sl_44
L_sl_43:
    s_nop 4
    v_mfma_f32_16x16x32_bf16 v[88:91], v[152:155], v[244:247], v[200:203]
L_sl_44:
    s_waitcnt lgkmcnt(2)
    s_cmp_gt_i32 s58, 15
    s_cbranch_scc1 L_sl_45
    v_mfma_f32_16x16x32_bf16 v[92:95], v[156:159], v[244:247], 0
    s_branch L_sl_46
L_sl_45:
    s_nop 4
    v_mfma_f32_16x16x32_bf16 v[92:95], v[156:159], v[244:247], v[200:203]
L_sl_46:
    s_waitcnt lgkmcnt(1)
    s_cmp_gt_i32 s58, 16
    s_cbranch_scc1 L_sl_47
    v_mfma_f32_16x16x32_bf16 v[96:99], v[144:147], v[244:247], v[192:195]
    s_branch L_sl_48
L_sl_47:
    s_nop 4
    v_mfma_f32_16x16x32_bf16 v[96:99], v[144:147], v[244:247], v[200:203]
L_sl_48:
    s_waitcnt lgkmcnt(0)
    s_cmp_gt_i32 s58, 17
    s_cbranch_scc1 L_sl_49
    v_mfma_f32_16x16x32_bf16 v[100:103], v[148:151], v[244:247], v[196:199]
    s_branch L_sl_50
L_sl_49:
    s_nop 4
    v_mfma_f32_16x16x32_bf16 v[100:103], v[148:151], v[244:247], v[200:203]
L_sl_50:
L_a_join:
    s_nop 7
    s_waitcnt vmcnt(0)
    v_mov_b32 v252, 159240
    v_mov_b32 v253, 1
    s_mov_b64 exec, 1
    ds_add_rtn_u32 v254, v252, v253
    s_mov_b64 exec, -1
    s_waitcnt lgkmcnt(0)
    v_readfirstlane_b32 s92, v254
    s_nop 3
    s_cmp_lg_u32 s92, 7
    s_cbranch_scc1 L_arr_51
    v_mov_b32 v252, 159232
    ds_read_b64 v[248:249], v252
    s_waitcnt lgkmcnt(0)
    v_readfirstlane_b32 s90, v248
    v_readfirstlane_b32 s91, v249
    s_nop 3
    s_lshl_b32 s92, s94, 3
    s_add_u32 s92, s92, 25167872
    v_mov_b32 v248, s90
    v_mov_b32 v249, s91
    v_mov_b32 v255, s92
    s_mov_b64 exec, 1
    buffer_store_dwordx2 v[248:249], v255, s[96:99], 0 offen sc1
    s_mov_b64 exec, -1
L_arr_51:
    s_add_u32 s53, s46, 6
    s_and_b32 s53, s53, 7
    s_and_b32 s61, s2, 7
    s_lshl_b32 s61, s61, 2
    s_lshr_b32 s49, s2, 3
    s_and_b32 s49, s49, 3
    s_add_u32 s61, s61, s49
    s_lshr_b32 s62, s2, 5
    s_mov_b32 s24, s16
    s_and_b32 s25, s17, 0xffff
    s_mov_b32 s26, 0x188000
    s_mov_b32 s27, 0x00020000
    s_mov_b32 s28, s8
    s_and_b32 s29, s9, 0xffff
    s_mov_b32 s30, 0x62000
    s_mov_b32 s31, 0x00020000
    s_mov_b32 s36, s4
    s_and_b32 s37, s5, 0xffff
    s_mov_b32 s38, 0x1c0000
    s_mov_b32 s39, 0x00020000
    s_mov_b32 s32, s18
    s_and_b32 s33, s19, 0xffff
    s_mov_b32 s34, 0x1c0000
    s_mov_b32 s35, 0x00020000
    v_lshrrev_b32 v12, 3, v1
    v_mul_u32_u24 v240, 896, v12
    v_bfe_u32 v13, v1, 4, 1
    v_lshlrev_b32 v13, 2, v13
    v_and_b32 v12, 7, v1
    v_xor_b32 v12, v12, v13
    v_lshl_add_u32 v240, v12, 4, v240
    s_lshl_b32 s49, s62, 7
    v_add_u32 v240, s49, v240
    s_lshl_b32 s64, s53, 14
    s_add_u32 s64, s64, 24576
    s_cmp_eq_u32 s53, 7
    s_cselect_b32 s64, 154112, s64
    s_mul_i32 s63, s53, 10
    s_mul_i32 s49, s53, 9
    s_add_u32 s49, s49, 2
    s_cmp_ge_u32 s53, 2
    s_cselect_b32 s63, s49, s63
    s_sub_u32 s49, s53, 6
    s_lshl_b32 s49, s49, 3
    s_cmp_ge_u32 s53, 6
    s_cselect_b32 s63, s49, s63
    s_mul_i32 s65, s63, 28672
    s_mul_i32 s49, s63, 25088
    s_cselect_b32 s65, s49, s65
    s_cmp_ge_u32 s2, 224
    s_cbranch_scc1 L_s3p_52
    s_cmp_ge_u32 s53, 6
    s_cbranch_scc1 L_s3pe_53
    s_add_u32 m0, s64, 0
    s_add_u32 s52, s65, 0
    buffer_load_dwordx4 v240, s[24:27], s52 offen lds
    s_add_u32 m0, s64, 1024
    s_add_u32 s52, s65, 7168
    buffer_load_dwordx4 v240, s[24:27], s52 offen lds
    s_add_u32 m0, s64, 2048
    s_add_u32 s52, s65, 14336
    buffer_load_dwordx4 v240, s[24:27], s52 offen lds
    s_add_u32 m0, s64, 3072
    s_add_u32 s52, s65, 21504
    buffer_load_dwordx4 v240, s[24:27], s52 offen lds
    s_add_u32 m0, s64, 4096
    s_add_u32 s52, s65, 28672
    buffer_load_dwordx4 v240, s[24:27], s52 offen lds
    s_add_u32 m0, s64, 5120
    s_add_u32 s52, s65, 35840
    buffer_load_dwordx4 v240, s[24:27], s52 offen lds
    s_add_u32 m0, s64, 6144
    s_add_u32 s52, s65, 43008
    buffer_load_dwordx4 v240, s[24:27], s52 offen lds
    s_add_u32 m0, s64, 7168
    s_add_u32 s52, s65, 50176
    buffer_load_dwordx4 v240, s[24:27], s52 offen lds
    s_add_u32 m0, s64, 8192
    s_add_u32 s52, s65, 57344
    buffer_load_dwordx4 v240, s[24:27], s52 offen lds
    s_add_u32 m0, s64, 9216
    s_add_u32 s52, s65, 64512
    buffer_load_dwordx4 v240, s[24:27], s52 offen lds
    s_add_u32 m0, s64, 10240
    s_add_u32 s52, s65, 71680
    buffer_load_dwordx4 v240, s[24:27], s52 offen lds
    s_add_u32 m0, s64, 11264
    s_add_u32 s52, s65, 78848
    buffer_load_dwordx4 v240, s[24:27], s52 offen lds
    s_add_u32 m0, s64, 12288
    s_add_u32 s52, s65, 86016
    buffer_load_dwordx4 v240, s[24:27], s52 offen lds
    s_add_u32 m0, s64, 13312
    s_add_u32 s52, s65, 93184
    buffer_load_dwordx4 v240, s[24:27], s52 offen lds
    s_add_u32 m0, s64, 14336
    s_add_u32 s52, s65, 100352
    buffer_load_dwordx4 v240, s[24:27], s52 offen lds
    s_add_u32 m0, s64, 15360
    s_add_u32 s52, s65, 107520
    buffer_load_dwordx4 v240, s[24:27], s52 offen lds
    s_branch L_s3p_52
L_s3pe_53:
    s_add_u32 m0, s64, 0
    s_add_u32 s52, s65, 0
    buffer_load_dwordx4 v240, s[28:31], s52 offen lds
    s_add_u32 m0, s64, 1024
    s_add_u32 s52, s65, 7168
    buffer_load_dwordx4 v240, s[28:31], s52 offen lds
    s_add_u32 m0, s64, 2048
    s_add_u32 s52, s65, 14336
    buffer_load_dwordx4 v240, s[28:31], s52 offen lds
    s_add_u32 m0, s64, 3072
    s_add_u32 s52, s65, 21504
    buffer_load_dwordx4 v240, s[28:31], s52 offen lds
L_s3p_52:
    s_nop 0
    ds_read_b64_tr_b16 v[160:161], v9 offset:0
    ds_read_b64_tr_b16 v[162:163], v9 offset:1024
    ds_read_b64_tr_b16 v[164:165], v9 offset:512
    ds_read_b64_tr_b16 v[166:167], v9 offset:1536
    v_max3_f32 v12, v32, v33, v34
    v_max3_f32 v13, v35, v36, v37
    v_max3_f32 v12, v12, v38, v39
    v_max3_f32 v13, v13, v40, v41
    v_max3_f32 v12, v12, v42, v43
    v_max3_f32 v13, v13, v44, v45
    v_max3_f32 v12, v12, v46, v47
    v_max3_f32 v13, v13, v48, v49
    v_max3_f32 v12, v12, v50, v51
    v_max3_f32 v13, v13, v52, v53
    v_max3_f32 v12, v12, v54, v55
    v_max3_f32 v13, v13, v56, v57
    v_max3_f32 v12, v12, v58, v59
    v_max3_f32 v13, v13, v60, v61
    v_max3_f32 v12, v12, v62, v63
    v_max3_f32 v13, v13, v64, v65
    v_max3_f32 v12, v12, v66, v67
    v_max3_f32 v13, v13, v68, v69
    v_max3_f32 v12, v12, v70, v71
    v_max3_f32 v13, v13, v72, v73
    v_max3_f32 v12, v12, v74, v75
    v_max3_f32 v13, v13, v76, v77
    v_max3_f32 v12, v12, v78, v79
    v_max3_f32 v13, v13, v80, v81
    v_max3_f32 v12, v12, v82, v83
    v_max3_f32 v13, v13, v84, v85
    v_max3_f32 v12, v12, v86, v87
    v_max3_f32 v13, v13, v88, v89
    v_max3_f32 v12, v12, v90, v91
    v_max3_f32 v13, v13, v92, v93
    v_max3_f32 v12, v12, v94, v95
    v_max3_f32 v13, v13, v96, v97
    v_max3_f32 v12, v12, v98, v99
    v_max3_f32 v13, v13, v100, v101
    v_max3_f32 v12, v12, v102, v103
    v_max_f32 v12, v12, v13
    v_mov_b32 v13, v12
    s_nop 1
    v_permlane16_swap_b32 v12, v13
    v_max_f32 v12, v12, v13
    v_mov_b32 v13, v12
    s_nop 1
    v_permlane32_swap_b32 v12, v13
    v_max_f32 v12, v12, v13
    v_mov_b32 v15, 0x3e8b97f6
    v_mul_f32 v12, v15, v12
    v_fma_f32 v32, v32, v15, -v12
    v_fma_f32 v33, v33, v15, -v12
    v_fma_f32 v34, v34, v15, -v12
    v_fma_f32 v35, v35, v15, -v12
    v_fma_f32 v36, v36, v15, -v12
    v_fma_f32 v37, v37, v15, -v12
    v_fma_f32 v38, v38, v15, -v12
    v_fma_f32 v39, v39, v15, -v12
    v_exp_f32 v32, v32
    v_exp_f32 v33, v33
    v_exp_f32 v34, v34
    v_exp_f32 v35, v35
    v_exp_f32 v36, v36
    v_exp_f32 v37, v37
    v_exp_f32 v38, v38
    v_exp_f32 v39, v39
    v_cvt_pk_bf16_f32 v104, v32, v33
    v_cvt_pk_bf16_f32 v105, v34, v35
    v_cvt_pk_bf16_f32 v106, v36, v37
    v_cvt_pk_bf16_f32 v107, v38, v39
    ds_read_b64_tr_b16 v[168:169], v9 offset:2048
    ds_read_b64_tr_b16 v[170:171], v9 offset:3072
    ds_read_b64_tr_b16 v[172:173], v9 offset:2560
    ds_read_b64_tr_b16 v[174:175], v9 offset:3584
    s_waitcnt lgkmcnt(6)
    v_mfma_f32_16x16x32_bf16 v[176:179], v[160:163], v[104:107], 0
    s_waitcnt lgkmcnt(4)
    v_mfma_f32_16x16x32_bf16 v[180:183], v[164:167], v[104:107], 0
    v_fma_f32 v40, v40, v15, -v12
    v_fma_f32 v41, v41, v15, -v12
    v_fma_f32 v42, v42, v15, -v12
    v_fma_f32 v43, v43, v15, -v12
    v_fma_f32 v44, v44, v15, -v12
    v_fma_f32 v45, v45, v15, -v12
    v_fma_f32 v46, v46, v15, -v12
    v_fma_f32 v47, v47, v15, -v12
    v_exp_f32 v40, v40
    v_exp_f32 v41, v41
    v_exp_f32 v42, v42
    v_exp_f32 v43, v43
    v_exp_f32 v44, v44
    v_exp_f32 v45, v45
    v_exp_f32 v46, v46
    v_exp_f32 v47, v47
    v_cvt_pk_bf16_f32 v108, v40, v41
    v_cvt_pk_bf16_f32 v109, v42, v43
    v_cvt_pk_bf16_f32 v110, v44, v45
    v_cvt_pk_bf16_f32 v111, v46, v47
    ds_read_b64_tr_b16 v[160:161], v9 offset:4096
    ds_read_b64_tr_b16 v[162:163], v9 offset:5120
    ds_read_b64_tr_b16 v[164:165], v9 offset:4608
    ds_read_b64_tr_b16 v[166:167], v9 offset:5632
    s_waitcnt lgkmcnt(6)
    v_mfma_f32_16x16x32_bf16 v[176:179], v[168:171], v[108:111], v[176:179]
    s_waitcnt lgkmcnt(4)
    v_mfma_f32_16x16x32_bf16 v[180:183], v[172:175], v[108:111], v[180:183]
    v_fma_f32 v48, v48, v15, -v12
    v_fma_f32 v49, v49, v15, -v12
    v_fma_f32 v50, v50, v15, -v12
    v_fma_f32 v51, v51, v15, -v12
    v_fma_f32 v52, v52, v15, -v12
    v_fma_f32 v53, v53, v15, -v12
    v_fma_f32 v54, v54, v15, -v12
    v_fma_f32 v55, v55, v15, -v12
    v_exp_f32 v48, v48
    v_exp_f32 v49, v49
    v_exp_f32 v50, v50
    v_exp_f32 v51, v51
    v_exp_f32 v52, v52
    v_exp_f32 v53, v53
    v_exp_f32 v54, v54
    v_exp_f32 v55, v55
    v_cvt_pk_bf16_f32 v112, v48, v49
    v_cvt_pk_bf16_f32 v113, v50, v51
    v_cvt_pk_bf16_f32 v114, v52, v53
    v_cvt_pk_bf16_f32 v115, v54, v55
    ds_read_b64_tr_b16 v[168:169], v9 offset:6144
    ds_read_b64_tr_b16 v[170:171], v9 offset:7168
    ds_read_b64_tr_b16 v[172:173], v9 offset:6656
    ds_read_b64_tr_b16 v[174:175], v9 offset:7680
    s_waitcnt lgkmcnt(6)
    v_mfma_f32_16x16x32_bf16 v[176:179], v[160:163], v[112:115], v[176:179]
    s_waitcnt lgkmcnt(4)
    v_mfma_f32_16x16x32_bf16 v[180:183], v[164:167], v[112:115], v[180:183]
    v_fma_f32 v56, v56, v15, -v12
    v_fma_f32 v57, v57, v15, -v12
    v_fma_f32 v58, v58, v15, -v12
    v_fma_f32 v59, v59, v15, -v12
    v_fma_f32 v60, v60, v15, -v12
    v_fma_f32 v61, v61, v15, -v12
    v_fma_f32 v62, v62, v15, -v12
    v_fma_f32 v63, v63, v15, -v12
    v_exp_f32 v56, v56
    v_exp_f32 v57, v57
    v_exp_f32 v58, v58
    v_exp_f32 v59, v59
    v_exp_f32 v60, v60
    v_exp_f32 v61, v61
    v_exp_f32 v62, v62
    v_exp_f32 v63, v63
    v_cvt_pk_bf16_f32 v116, v56, v57
    v_cvt_pk_bf16_f32 v117, v58, v59
    v_cvt_pk_bf16_f32 v118, v60, v61
    v_cvt_pk_bf16_f32 v119, v62, v63
    ds_read_b64_tr_b16 v[160:161], v9 offset:8192
    ds_read_b64_tr_b16 v[162:163], v9 offset:9216
    ds_read_b64_tr_b16 v[164:165], v9 offset:8704
    ds_read_b64_tr_b16 v[166:167], v9 offset:9728
    s_waitcnt lgkmcnt(6)
    v_mfma_f32_16x16x32_bf16 v[176:179], v[168:171], v[116:119], v[176:179]
    s_waitcnt lgkmcnt(4)
    v_mfma_f32_16x16x32_bf16 v[180:183], v[172:175], v[116:119], v[180:183]
    v_fma_f32 v64, v64, v15, -v12
    v_fma_f32 v65, v65, v15, -v12
    v_fma_f32 v66, v66, v15, -v12
    v_fma_f32 v67, v67, v15, -v12
    v_fma_f32 v68, v68, v15, -v12
    v_fma_f32 v69, v69, v15, -v12
    v_fma_f32 v70, v70, v15, -v12
    v_fma_f32 v71, v71, v15, -v12
    v_exp_f32 v64, v64
    v_exp_f32 v65, v65
    v_exp_f32 v66, v66
    v_exp_f32 v67, v67
    v_exp_f32 v68, v68
    v_exp_f32 v69, v69
    v_exp_f32 v70, v70
    v_exp_f32 v71, v71
    v_cvt_pk_bf16_f32 v120, v64, v65
    v_cvt_pk_bf16_f32 v121, v66, v67
    v_cvt_pk_bf16_f32 v122, v68, v69
    v_cvt_pk_bf16_f32 v123, v70, v71
    ds_read_b64_tr_b16 v[168:169], v9 offset:10240
    ds_read_b64_tr_b16 v[170:171], v9 offset:11264
    ds_read_b64_tr_b16 v[172:173], v9 offset:10752
    ds_read_b64_tr_b16 v[174:175], v9 offset:11776
    s_waitcnt lgkmcnt(6)
    v_mfma_f32_16x16x32_bf16 v[176:179], v[160:163], v[120:123], v[176:179]
    s_waitcnt lgkmcnt(4)
    v_mfma_f32_16x16x32_bf16 v[180:183], v[164:167], v[120:123], v[180:183]
    v_fma_f32 v72, v72, v15, -v12
    v_fma_f32 v73, v73, v15, -v12
    v_fma_f32 v74, v74, v15, -v12
    v_fma_f32 v75, v75, v15, -v12
    v_fma_f32 v76, v76, v15, -v12
    v_fma_f32 v77, v77, v15, -v12
    v_fma_f32 v78, v78, v15, -v12
    v_fma_f32 v79, v79, v15, -v12
    v_exp_f32 v72, v72
    v_exp_f32 v73, v73
    v_exp_f32 v74, v74
    v_exp_f32 v75, v75
    v_exp_f32 v76, v76
    v_exp_f32 v77, v77
    v_exp_f32 v78, v78
    v_exp_f32 v79, v79
    v_cvt_pk_bf16_f32 v124, v72, v73
    v_cvt_pk_bf16_f32 v125, v74, v75
    v_cvt_pk_bf16_f32 v126, v76, v77
    v_cvt_pk_bf16_f32 v127, v78, v79
    ds_read_b64_tr_b16 v[160:161], v9 offset:12288
    ds_read_b64_tr_b16 v[162:163], v9 offset:13312
    ds_read_b64_tr_b16 v[164:165], v9 offset:12800
    ds_read_b64_tr_b16 v[166:167], v9 offset:13824
    s_waitcnt lgkmcnt(6)
    v_mfma_f32_16x16x32_bf16 v[176:179], v[168:171], v[124:127], v[176:179]
    s_waitcnt lgkmcnt(4)
    v_mfma_f32_16x16x32_bf16 v[180:183], v[172:175], v[124:127], v[180:183]
    v_fma_f32 v80, v80, v15, -v12
    v_fma_f32 v81, v81, v15, -v12
    v_fma_f32 v82, v82, v15, -v12
    v_fma_f32 v83, v83, v15, -v12
    v_fma_f32 v84, v84, v15, -v12
    v_fma_f32 v85, v85, v15, -v12
    v_fma_f32 v86, v86, v15, -v12
    v_fma_f32 v87, v87, v15, -v12
    v_exp_f32 v80, v80
    v_exp_f32 v81, v81
    v_exp_f32 v82, v82
    v_exp_f32 v83, v83
    v_exp_f32 v84, v84
    v_exp_f32 v85, v85
    v_exp_f32 v86, v86
    v_exp_f32 v87, v87
    v_cvt_pk_bf16_f32 v128, v80, v81
    v_cvt_pk_bf16_f32 v129, v82, v83
    v_cvt_pk_bf16_f32 v130, v84, v85
    v_cvt_pk_bf16_f32 v131, v86, v87
    ds_read_b64_tr_b16 v[168:169], v9 offset:14336
    ds_read_b64_tr_b16 v[170:171], v9 offset:15360
    ds_read_b64_tr_b16 v[172:173], v9 offset:14848
    ds_read_b64_tr_b16 v[174:175], v9 offset:15872
    s_waitcnt lgkmcnt(6)
    v_mfma_f32_16x16x32_bf16 v[176:179], v[160:163], v[128:131], v[176:179]
    s_waitcnt lgkmcnt(4)
    v_mfma_f32_16x16x32_bf16 v[180:183], v[164:167], v[128:131], v[180:183]
    v_fma_f32 v88, v88, v15, -v12
    v_fma_f32 v89, v89, v15, -v12
    v_fma_f32 v90, v90, v15, -v12
    v_fma_f32 v91, v91, v15, -v12
    v_fma_f32 v92, v92, v15, -v12
    v_fma_f32 v93, v93, v15, -v12
    v_fma_f32 v94, v94, v15, -v12
    v_fma_f32 v95, v95, v15, -v12
    v_exp_f32 v88, v88
    v_exp_f32 v89, v89
    v_exp_f32 v90, v90
    v_exp_f32 v91, v91
    v_exp_f32 v92, v92
    v_exp_f32 v93, v93
    v_exp_f32 v94, v94
    v_exp_f32 v95, v95
    v_cvt_pk_bf16_f32 v132, v88, v89
    v_cvt_pk_bf16_f32 v133, v90, v91
    v_cvt_pk_bf16_f32 v134, v92, v93
    v_cvt_pk_bf16_f32 v135, v94, v95
    ds_read_b64_tr_b16 v[160:161], v9 offset:16384
    ds_read_b64_tr_b16 v[162:163], v9 offset:17408
    ds_read_b64_tr_b16 v[164:165], v9 offset:16896
    ds_read_b64_tr_b16 v[166:167], v9 offset:17920
    s_waitcnt lgkmcnt(6)
    v_mfma_f32_16x16x32_bf16 v[176:179], v[168:171], v[132:135], v[176:179]
    s_waitcnt lgkmcnt(4)
    v_mfma_f32_16x16x32_bf16 v[180:183], v[172:175], v[132:135], v[180:183]
    v_fma_f32 v96, v96, v15, -v12
    v_fma_f32 v97, v97, v15, -v12
    v_fma_f32 v98, v98, v15, -v12
    v_fma_f32 v99, v99, v15, -v12
    v_fma_f32 v100, v100, v15, -v12
    v_fma_f32 v101, v101, v15, -v12
    v_fma_f32 v102, v102, v15, -v12
    v_fma_f32 v103, v103, v15, -v12
    v_exp_f32 v96, v96
    v_exp_f32 v97, v97
    v_exp_f32 v98, v98
    v_exp_f32 v99, v99
    v_exp_f32 v100, v100
    v_exp_f32 v101, v101
    v_exp_f32 v102, v102
    v_exp_f32 v103, v103
    v_cvt_pk_bf16_f32 v136, v96, v97
    v_cvt_pk_bf16_f32 v137, v98, v99
    v_cvt_pk_bf16_f32 v138, v100, v101
    v_cvt_pk_bf16_f32 v139, v102, v103
    s_waitcnt lgkmcnt(2)
    s_nop 0
    v_mfma_f32_16x16x32_bf16 v[176:179], v[160:163], v[136:139], v[176:179]
    s_waitcnt lgkmcnt(0)
    v_mfma_f32_16x16x32_bf16 v[180:183], v[164:167], v[136:139], v[180:183]
    v_and_b32 v13, 15, v1
    v_add_u32 v13, 48, v13
    v_lshlrev_b32 v13, 2, v13
    s_nop 4
    ds_bpermute_b32 v14, v13, v180
    v_cmp_le_u32 vcc, 48, v1
    s_waitcnt lgkmcnt(0)
    v_rcp_f32 v14, v14
    s_nop 0
    v_mul_f32 v176, v176, v14
    v_mul_f32 v177, v177, v14
    v_mul_f32 v178, v178, v14
    v_mul_f32 v179, v179, v14
    v_mul_f32 v180, v180, v14
    v_mul_f32 v181, v181, v14
    v_mul_f32 v182, v182, v14
    v_mul_f32 v183, v183, v14
    v_cndmask_b32 v180, v180, 0, vcc
    v_cndmask_b32 v181, v181, 0, vcc
    v_cndmask_b32 v182, v182, 0, vcc
    v_cndmask_b32 v183, v183, 0, vcc
    v_cvt_pk_bf16_f32 v104, v176, v177
    v_cvt_pk_bf16_f32 v105, v178, v179
    v_cvt_pk_bf16_f32 v106, v180, v181
    v_cvt_pk_bf16_f32 v107, v182, v183
    buffer_store_dwordx4 v[104:107], v2, s[40:43], s55 offen sc1
    v_lshrrev_b32 v2, 5, v1
    v_lshlrev_b32 v3, 4, v1
    v_and_b32 v12, 15, v1
    v_lshrrev_b32 v13, 2, v12
    v_lshl_add_u32 v13, v2, 2, v13
    v_lshlrev_b32 v5, 7, v13
    v_bfe_u32 v13, v1, 4, 1
    v_lshlrev_b32 v13, 1, v13
    v_bfe_u32 v14, v1, 1, 1
    v_add_u32 v13, v13, v14
    v_bfe_u32 v14, v1, 3, 1
    v_lshlrev_b32 v14, 2, v14
    v_xor_b32 v13, v13, v14
    v_lshl_add_u32 v5, v13, 4, v5
    v_and_b32 v13, 1, v1
    v_lshl_add_u32 v5, v13, 3, v5
    v_bfe_u32 v12, v1, 4, 1
    v_lshlrev_b32 v6, 14, v12
    v_lshl_add_u32 v6, v2, 8, v6
    v_and_b32 v12, 15, v1
    v_lshl_add_u32 v6, v12, 4, v6
    v_add_u32 v5, s64, v5
    s_cmp_lt_u32 s2, 224
    s_cbranch_scc1 L_s3x_54
    s_waitcnt vmcnt(0)
    v_mov_b32 v252, 159244
    v_mov_b32 v253, 1
    s_mov_b64 exec, 1
    ds_add_rtn_u32 v254, v252, v253
    s_mov_b64 exec, -1
    s_waitcnt lgkmcnt(0)
    v_readfirstlane_b32 s92, v254
    s_nop 3
    s_cmp_lg_u32 s92, 7
    s_cbranch_scc1 L_arr_55
    v_mov_b32 v252, 159232
    ds_read_b64 v[248:249], v252
    s_waitcnt lgkmcnt(0)
    v_readfirstlane_b32 s90, v248
    v_readfirstlane_b32 s91, v249
    s_nop 3
    s_lshl_b32 s92, s94, 3
    s_add_u32 s92, s92, 25169920
    v_mov_b32 v248, s90
    v_mov_b32 v249, s91
    v_mov_b32 v255, s92
    s_mov_b64 exec, 1
    buffer_store_dwordx2 v[248:249], v255, s[96:99], 0 offen sc1
    s_mov_b64 exec, -1
L_arr_55:
    s_branch L_exit
L_s3x_54:
    s_cmp_ge_u32 s53, 6
    s_cbranch_scc1 L_s3_E
    v_xor_b32 v15, 64, v5
    s_cmp_ge_u32 s53, 2
    s_cbranch_scc1 L_s3_D9
    s_waitcnt vmcnt(13)
    ds_read_b64_tr_b16 v[128:129], v5 offset:0
    ds_read_b64_tr_b16 v[130:131], v5 offset:1024
    ds_read_b64_tr_b16 v[132:133], v15 offset:0
    ds_read_b64_tr_b16 v[134:135], v15 offset:1024
    ds_read_b64_tr_b16 v[136:137], v5 offset:2048
    ds_read_b64_tr_b16 v[138:139], v5 offset:3072
    ds_read_b64_tr_b16 v[140:141], v15 offset:2048
    ds_read_b64_tr_b16 v[142:143], v15 offset:3072
    s_waitcnt vmcnt(0)
    v_mov_b32 v252, 159244
    v_mov_b32 v253, 1
    s_mov_b64 exec, 1
    ds_add_rtn_u32 v254, v252, v253
    s_mov_b64 exec, -1
    s_waitcnt lgkmcnt(0)
    v_readfirstlane_b32 s92, v254
    s_nop 3
    s_cmp_lg_u32 s92, 7
    s_cbranch_scc1 L_arr_56
    v_mov_b32 v252, 159232
    ds_read_b64 v[248:249], v252
    s_waitcnt lgkmcnt(0)
    v_readfirstlane_b32 s90, v248
    v_readfirstlane_b32 s91, v249
    s_nop 3
    s_lshl_b32 s92, s94, 3
    s_add_u32 s92, s92, 25169920
    v_mov_b32 v248, s90
    v_mov_b32 v249, s91
    v_mov_b32 v255, s92
    s_mov_b64 exec, 1
    buffer_store_dwordx2 v[248:249], v255, s[96:99], 0 offen sc1
    s_mov_b64 exec, -1
L_arr_56:
    s_waitcnt lgkmcnt(0)
    s_add_u32 m0, s64, 0
    s_add_u32 s52, s65, 114688
    buffer_load_dwordx4 v240, s[24:27], s52 offen lds
    s_add_u32 m0, s64, 1024
    s_add_u32 s52, s65, 121856
    buffer_load_dwordx4 v240, s[24:27], s52 offen lds
    s_add_u32 m0, s64, 2048
    s_add_u32 s52, s65, 129024
    buffer_load_dwordx4 v240, s[24:27], s52 offen lds
    s_add_u32 m0, s64, 3072
    s_add_u32 s52, s65, 136192
    buffer_load_dwordx4 v240, s[24:27], s52 offen lds
    s_waitcnt vmcnt(13)
    ds_read_b64_tr_b16 v[144:145], v5 offset:4096
    ds_read_b64_tr_b16 v[146:147], v5 offset:5120
    ds_read_b64_tr_b16 v[148:149], v15 offset:4096
    ds_read_b64_tr_b16 v[150:151], v15 offset:5120
    ds_read_b64_tr_b16 v[152:153], v5 offset:6144
    ds_read_b64_tr_b16 v[154:155], v5 offset:7168
    ds_read_b64_tr_b16 v[156:157], v15 offset:6144
    ds_read_b64_tr_b16 v[158:159], v15 offset:7168
    s_waitcnt lgkmcnt(0)
    s_add_u32 m0, s64, 4096
    s_add_u32 s52, s65, 143360
    buffer_load_dwordx4 v240, s[24:27], s52 offen lds
    s_add_u32 m0, s64, 5120
    s_add_u32 s52, s65, 150528
    buffer_load_dwordx4 v240, s[24:27], s52 offen lds
    s_add_u32 m0, s64, 6144
    s_add_u32 s52, s65, 157696
    buffer_load_dwordx4 v240, s[24:27], s52 offen lds
    s_add_u32 m0, s64, 7168
    s_add_u32 s52, s65, 164864
    buffer_load_dwordx4 v240, s[24:27], s52 offen lds
    s_waitcnt vmcnt(13)
    ds_read_b64_tr_b16 v[160:161], v5 offset:8192
    ds_read_b64_tr_b16 v[162:163], v5 offset:9216
    ds_read_b64_tr_b16 v[164:165], v15 offset:8192
    ds_read_b64_tr_b16 v[166:167], v15 offset:9216
    ds_read_b64_tr_b16 v[168:169], v5 offset:10240
    ds_read_b64_tr_b16 v[170:171], v5 offset:11264
    ds_read_b64_tr_b16 v[172:173], v15 offset:10240
    ds_read_b64_tr_b16 v[174:175], v15 offset:11264
    s_waitcnt lgkmcnt(0)
    s_add_u32 m0, s64, 8192
    s_add_u32 s52, s65, 172032
    buffer_load_dwordx4 v240, s[24:27], s52 offen lds
    s_add_u32 m0, s64, 9216
    s_add_u32 s52, s65, 179200
    buffer_load_dwordx4 v240, s[24:27], s52 offen lds
    s_add_u32 m0, s64, 10240
    s_add_u32 s52, s65, 186368
    buffer_load_dwordx4 v240, s[24:27], s52 offen lds
    s_add_u32 m0, s64, 11264
    s_add_u32 s52, s65, 193536
    buffer_load_dwordx4 v240, s[24:27], s52 offen lds
    s_waitcnt vmcnt(13)
    ds_read_b64_tr_b16 v[176:177], v5 offset:12288
    ds_read_b64_tr_b16 v[178:179], v5 offset:13312
    ds_read_b64_tr_b16 v[180:181], v15 offset:12288
    ds_read_b64_tr_b16 v[182:183], v15 offset:13312
    ds_read_b64_tr_b16 v[184:185], v5 offset:14336
    ds_read_b64_tr_b16 v[186:187], v5 offset:15360
    ds_read_b64_tr_b16 v[188:189], v15 offset:14336
    ds_read_b64_tr_b16 v[190:191], v15 offset:15360
    s_waitcnt lgkmcnt(0)
    s_add_u32 m0, s64, 12288
    s_add_u32 s52, s65, 200704
    buffer_load_dwordx4 v240, s[24:27], s52 offen lds
    s_add_u32 m0, s64, 13312
    s_add_u32 s52, s65, 207872
    buffer_load_dwordx4 v240, s[24:27], s52 offen lds
    s_add_u32 m0, s64, 14336
    s_add_u32 s52, s65, 215040
    buffer_load_dwordx4 v240, s[24:27], s52 offen lds
    s_add_u32 m0, s64, 15360
    s_add_u32 s52, s65, 222208
    buffer_load_dwordx4 v240, s[24:27], s52 offen lds
    s_waitcnt vmcnt(12)
    ds_read_b64_tr_b16 v[192:193], v5 offset:0
    ds_read_b64_tr_b16 v[194:195], v5 offset:1024
    ds_read_b64_tr_b16 v[196:197], v15 offset:0
    ds_read_b64_tr_b16 v[198:199], v15 offset:1024
    ds_read_b64_tr_b16 v[200:201], v5 offset:2048
    ds_read_b64_tr_b16 v[202:203], v5 offset:3072
    ds_read_b64_tr_b16 v[204:205], v15 offset:2048
    ds_read_b64_tr_b16 v[206:207], v15 offset:3072
    s_waitcnt lgkmcnt(0)
    s_add_u32 m0, s64, 0
    s_add_u32 s52, s65, 229376
    buffer_load_dwordx4 v240, s[24:27], s52 offen lds
    s_add_u32 m0, s64, 1024
    s_add_u32 s52, s65, 236544
    buffer_load_dwordx4 v240, s[24:27], s52 offen lds
    s_add_u32 m0, s64, 2048
    s_add_u32 s52, s65, 243712
    buffer_load_dwordx4 v240, s[24:27], s52 offen lds
    s_add_u32 m0, s64, 3072
    s_add_u32 s52, s65, 250880
    buffer_load_dwordx4 v240, s[24:27], s52 offen lds
    s_waitcnt vmcnt(12)
    ds_read_b64_tr_b16 v[208:209], v5 offset:4096
    ds_read_b64_tr_b16 v[210:211], v5 offset:5120
    ds_read_b64_tr_b16 v[212:213], v15 offset:4096
    ds_read_b64_tr_b16 v[214:215], v15 offset:5120
    ds_read_b64_tr_b16 v[216:217], v5 offset:6144
    ds_read_b64_tr_b16 v[218:219], v5 offset:7168
    ds_read_b64_tr_b16 v[220:221], v15 offset:6144
    ds_read_b64_tr_b16 v[222:223], v15 offset:7168
    s_waitcnt lgkmcnt(0)
    s_add_u32 m0, s64, 4096
    s_add_u32 s52, s65, 258048
    buffer_load_dwordx4 v240, s[24:27], s52 offen lds
    s_add_u32 m0, s64, 5120
    s_add_u32 s52, s65, 265216
    buffer_load_dwordx4 v240, s[24:27], s52 offen lds
    s_add_u32 m0, s64, 6144
    s_add_u32 s52, s65, 272384
    buffer_load_dwordx4 v240, s[24:27], s52 offen lds
    s_add_u32 m0, s64, 7168
    s_add_u32 s52, s65, 279552
    buffer_load_dwordx4 v240, s[24:27], s52 offen lds
    v_mov_b32 v252, 159232
    ds_read_b64 v[248:249], v252
    s_waitcnt lgkmcnt(0)
    v_readfirstlane_b32 s90, v248
    v_readfirstlane_b32 s91, v249
    s_nop 3
    s_lshr_b32 s49, s61, 1
    s_lshl_b32 s49, s49, 7
    s_add_u32 s49, s49, 25167872
    s_lshl_b32 s50, s63, 5
    s_mul_i32 s51, s50, 9363
    s_lshr_b32 s51, s51, 20
    s_add_u32 s50, s50, 319
    s_mul_i32 s50, s50, 9363
    s_lshr_b32 s50, s50, 20
    v_add_u32 v255, s51, v1
    v_min_u32 v255, s50, v255
    v_lshlrev_b32 v255, 3, v255
    v_add_u32 v255, s49, v255
    s_mov_b32 s95, 0
    s_mov_b64 exec, 15
L_poll_57:
    buffer_load_dwordx2 v[252:253], v255, s[96:99], 0 offen sc1
    s_waitcnt vmcnt(0)
    v_cmp_ne_u64 vcc, s[90:91], v[252:253]
    s_nop 1
    s_cmp_eq_u64 vcc, 0
    s_cbranch_scc1 L_polld_58
    s_sleep 2
    s_add_u32 s95, s95, 1
    s_cmp_lt_u32 s95, 0x40000
    s_cbranch_scc1 L_poll_57
L_polld_58:
    s_mov_b64 exec, -1
    s_mul_i32 s51, s61, 224
    s_lshl_b32 s52, s63, 1
    s_add_u32 s51, s51, s52
    s_lshl_b32 s51, s51, 10
    s_add_u32 s51, s51, 6291456
    s_add_u32 s52, s51, 0
    buffer_load_dwordx4 v[80:83], v3, s[40:43], s52 offen sc1
    s_add_u32 s52, s51, 114688
    buffer_load_dwordx4 v[84:87], v3, s[40:43], s52 offen sc1
    s_add_u32 s52, s51, 1024
    buffer_load_dwordx4 v[88:91], v3, s[40:43], s52 offen sc1
    s_add_u32 s52, s51, 115712
    buffer_load_dwordx4 v[92:95], v3, s[40:43], s52 offen sc1
    s_add_u32 s52, s51, 2048
    buffer_load_dwordx4 v[96:99], v3, s[40:43], s52 offen sc1
    s_add_u32 s52, s51, 116736
    buffer_load_dwordx4 v[100:103], v3, s[40:43], s52 offen sc1
    s_add_u32 s52, s51, 3072
    buffer_load_dwordx4 v[104:107], v3, s[40:43], s52 offen sc1
    s_add_u32 s52, s51, 117760
    buffer_load_dwordx4 v[108:111], v3, s[40:43], s52 offen sc1
    s_add_u32 s52, s51, 4096
    buffer_load_dwordx4 v[112:115], v3, s[40:43], s52 offen sc1
    s_add_u32 s52, s51, 118784
    buffer_load_dwordx4 v[116:119], v3, s[40:43], s52 offen sc1
    s_add_u32 s52, s51, 5120
    buffer_load_dwordx4 v[120:123], v3, s[40:43], s52 offen sc1
    s_add_u32 s52, s51, 119808
    buffer_load_dwordx4 v[124:127], v3, s[40:43], s52 offen sc1
    s_waitcnt vmcnt(8)
    v_mfma_f32_32x32x16_bf16 v[16:31], v[128:131], v[80:83], 0
    v_mfma_f32_32x32x16_bf16 v[32:47], v[128:131], v[84:87], 0
    v_mfma_f32_32x32x16_bf16 v[48:63], v[132:135], v[80:83], 0
    v_mfma_f32_32x32x16_bf16 v[64:79], v[132:135], v[84:87], 0
    v_mfma_f32_32x32x16_bf16 v[16:31], v[136:139], v[88:91], v[16:31]
    v_mfma_f32_32x32x16_bf16 v[32:47], v[136:139], v[92:95], v[32:47]
    v_mfma_f32_32x32x16_bf16 v[48:63], v[140:143], v[88:91], v[48:63]
    v_mfma_f32_32x32x16_bf16 v[64:79], v[140:143], v[92:95], v[64:79]
    s_add_u32 s52, s51, 6144
    buffer_load_dwordx4 v[80:83], v3, s[40:43], s52 offen sc1
    s_add_u32 s52, s51, 120832
    buffer_load_dwordx4 v[84:87], v3, s[40:43], s52 offen sc1
    s_add_u32 s52, s51, 7168
    buffer_load_dwordx4 v[88:91], v3, s[40:43], s52 offen sc1
    s_add_u32 s52, s51, 121856
    buffer_load_dwordx4 v[92:95], v3, s[40:43], s52 offen sc1
    s_waitcnt vmcnt(8)
    v_mfma_f32_32x32x16_bf16 v[16:31], v[144:147], v[96:99], v[16:31]
    v_mfma_f32_32x32x16_bf16 v[32:47], v[144:147], v[100:103], v[32:47]
    v_mfma_f32_32x32x16_bf16 v[48:63], v[148:151], v[96:99], v[48:63]
    v_mfma_f32_32x32x16_bf16 v[64:79], v[148:151], v[100:103], v[64:79]
    v_mfma_f32_32x32x16_bf16 v[16:31], v[152:155], v[104:107], v[16:31]
    v_mfma_f32_32x32x16_bf16 v[32:47], v[152:155], v[108:111], v[32:47]
    v_mfma_f32_32x32x16_bf16 v[48:63], v[156:159], v[104:107], v[48:63]
    v_mfma_f32_32x32x16_bf16 v[64:79], v[156:159], v[108:111], v[64:79]
    s_add_u32 s52, s51, 8192
    buffer_load_dwordx4 v[96:99], v3, s[40:43], s52 offen sc1
    s_add_u32 s52, s51, 122880
    buffer_load_dwordx4 v[100:103], v3, s[40:43], s52 offen sc1
    s_add_u32 s52, s51, 9216
    buffer_load_dwordx4 v[104:107], v3, s[40:43], s52 offen sc1
    s_add_u32 s52, s51, 123904
    buffer_load_dwordx4 v[108:111], v3, s[40:43], s52 offen sc1
    s_waitcnt vmcnt(8)
    v_mfma_f32_32x32x16_bf16 v[16:31], v[160:163], v[112:115], v[16:31]
    v_mfma_f32_32x32x16_bf16 v[32:47], v[160:163], v[116:119], v[32:47]
    v_mfma_f32_32x32x16_bf16 v[48:63], v[164:167], v[112:115], v[48:63]
    v_mfma_f32_32x32x16_bf16 v[64:79], v[164:167], v[116:119], v[64:79]
    v_mfma_f32_32x32x16_bf16 v[16:31], v[168:171], v[120:123], v[16:31]
    v_mfma_f32_32x32x16_bf16 v[32:47], v[168:171], v[124:127], v[32:47]
    v_mfma_f32_32x32x16_bf16 v[48:63], v[172:175], v[120:123], v[48:63]
    v_mfma_f32_32x32x16_bf16 v[64:79], v[172:175], v[124:127], v[64:79]
    s_add_u32 s52, s51, 10240
    buffer_load_dwordx4 v[112:115], v3, s[40:43], s52 offen sc1
    s_add_u32 s52, s51, 124928
    buffer_load_dwordx4 v[116:119], v3, s[40:43], s52 offen sc1
    s_add_u32 s52, s51, 11264
    buffer_load_dwordx4 v[120:123], v3, s[40:43], s52 offen sc1
    s_add_u32 s52, s51, 125952
    buffer_load_dwordx4 v[124:127], v3, s[40:43], s52 offen sc1
    s_waitcnt vmcnt(8)
    v_mfma_f32_32x32x16_bf16 v[16:31], v[176:179], v[80:83], v[16:31]
    v_mfma_f32_32x32x16_bf16 v[32:47], v[176:179], v[84:87], v[32:47]
    v_mfma_f32_32x32x16_bf16 v[48:63], v[180:183], v[80:83], v[48:63]
    v_mfma_f32_32x32x16_bf16 v[64:79], v[180:183], v[84:87], v[64:79]
    v_mfma_f32_32x32x16_bf16 v[16:31], v[184:187], v[88:91], v[16:31]
    v_mfma_f32_32x32x16_bf16 v[32:47], v[184:187], v[92:95], v[32:47]
    v_mfma_f32_32x32x16_bf16 v[48:63], v[188:191], v[88:91], v[48:63]
    v_mfma_f32_32x32x16_bf16 v[64:79], v[188:191], v[92:95], v[64:79]
    s_add_u32 s52, s51, 12288
    buffer_load_dwordx4 v[80:83], v3, s[40:43], s52 offen sc1
    s_add_u32 s52, s51, 126976
    buffer_load_dwordx4 v[84:87], v3, s[40:43], s52 offen sc1
    s_add_u32 s52, s51, 13312
    buffer_load_dwordx4 v[88:91], v3, s[40:43], s52 offen sc1
    s_add_u32 s52, s51, 128000
    buffer_load_dwordx4 v[92:95], v3, s[40:43], s52 offen sc1
    s_waitcnt vmcnt(8)
    v_mfma_f32_32x32x16_bf16 v[16:31], v[192:195], v[96:99], v[16:31]
    v_mfma_f32_32x32x16_bf16 v[32:47], v[192:195], v[100:103], v[32:47]
    v_mfma_f32_32x32x16_bf16 v[48:63], v[196:199], v[96:99], v[48:63]
    v_mfma_f32_32x32x16_bf16 v[64:79], v[196:199], v[100:103], v[64:79]
    v_mfma_f32_32x32x16_bf16 v[16:31], v[200:203], v[104:107], v[16:31]
    v_mfma_f32_32x32x16_bf16 v[32:47], v[200:203], v[108:111], v[32:47]
    v_mfma_f32_32x32x16_bf16 v[48:63], v[204:207], v[104:107], v[48:63]
    v_mfma_f32_32x32x16_bf16 v[64:79], v[204:207], v[108:111], v[64:79]
    s_add_u32 s52, s51, 14336
    buffer_load_dwordx4 v[96:99], v3, s[40:43], s52 offen sc1
    s_add_u32 s52, s51, 129024
    buffer_load_dwordx4 v[100:103], v3, s[40:43], s52 offen sc1
    s_add_u32 s52, s51, 15360
    buffer_load_dwordx4 v[104:107], v3, s[40:43], s52 offen sc1
    s_add_u32 s52, s51, 130048
    buffer_load_dwordx4 v[108:111], v3, s[40:43], s52 offen sc1
    s_waitcnt vmcnt(8)
    v_mfma_f32_32x32x16_bf16 v[16:31], v[208:211], v[112:115], v[16:31]
    v_mfma_f32_32x32x16_bf16 v[32:47], v[208:211], v[116:119], v[32:47]
    v_mfma_f32_32x32x16_bf16 v[48:63], v[212:215], v[112:115], v[48:63]
    v_mfma_f32_32x32x16_bf16 v[64:79], v[212:215], v[116:119], v[64:79]
    v_mfma_f32_32x32x16_bf16 v[16:31], v[216:219], v[120:123], v[16:31]
    v_mfma_f32_32x32x16_bf16 v[32:47], v[216:219], v[124:127], v[32:47]
    v_mfma_f32_32x32x16_bf16 v[48:63], v[220:223], v[120:123], v[48:63]
    v_mfma_f32_32x32x16_bf16 v[64:79], v[220:223], v[124:127], v[64:79]
    s_add_u32 s52, s51, 16384
    buffer_load_dwordx4 v[112:115], v3, s[40:43], s52 offen sc1
    s_add_u32 s52, s51, 131072
    buffer_load_dwordx4 v[116:119], v3, s[40:43], s52 offen sc1
    s_add_u32 s52, s51, 17408
    buffer_load_dwordx4 v[120:123], v3, s[40:43], s52 offen sc1
    s_add_u32 s52, s51, 132096
    buffer_load_dwordx4 v[124:127], v3, s[40:43], s52 offen sc1
    ds_read_b64_tr_b16 v[224:225], v5 offset:8192
    ds_read_b64_tr_b16 v[226:227], v5 offset:9216
    ds_read_b64_tr_b16 v[228:229], v15 offset:8192
    ds_read_b64_tr_b16 v[230:231], v15 offset:9216
    ds_read_b64_tr_b16 v[232:233], v5 offset:10240
    ds_read_b64_tr_b16 v[234:235], v5 offset:11264
    ds_read_b64_tr_b16 v[236:237], v15 offset:10240
    ds_read_b64_tr_b16 v[238:239], v15 offset:11264
    s_waitcnt vmcnt(8)
    s_waitcnt lgkmcnt(6)
    v_mfma_f32_32x32x16_bf16 v[16:31], v[224:227], v[80:83], v[16:31]
    v_mfma_f32_32x32x16_bf16 v[32:47], v[224:227], v[84:87], v[32:47]
    s_waitcnt lgkmcnt(4)
    v_mfma_f32_32x32x16_bf16 v[48:63], v[228:231], v[80:83], v[48:63]
    v_mfma_f32_32x32x16_bf16 v[64:79], v[228:231], v[84:87], v[64:79]
    s_waitcnt lgkmcnt(2)
    v_mfma_f32_32x32x16_bf16 v[16:31], v[232:235], v[88:91], v[16:31]
    v_mfma_f32_32x32x16_bf16 v[32:47], v[232:235], v[92:95], v[32:47]
    s_waitcnt lgkmcnt(0)
    v_mfma_f32_32x32x16_bf16 v[48:63], v[236:239], v[88:91], v[48:63]
    v_mfma_f32_32x32x16_bf16 v[64:79], v[236:239], v[92:95], v[64:79]
    s_add_u32 s52, s51, 18432
    buffer_load_dwordx4 v[80:83], v3, s[40:43], s52 offen sc1
    s_add_u32 s52, s51, 133120
    buffer_load_dwordx4 v[84:87], v3, s[40:43], s52 offen sc1
    s_add_u32 s52, s51, 19456
    buffer_load_dwordx4 v[88:91], v3, s[40:43], s52 offen sc1
    s_add_u32 s52, s51, 134144
    buffer_load_dwordx4 v[92:95], v3, s[40:43], s52 offen sc1
    ds_read_b64_tr_b16 v[224:225], v5 offset:12288
    ds_read_b64_tr_b16 v[226:227], v5 offset:13312
    ds_read_b64_tr_b16 v[228:229], v15 offset:12288
    ds_read_b64_tr_b16 v[230:231], v15 offset:13312
    ds_read_b64_tr_b16 v[232:233], v5 offset:14336
    ds_read_b64_tr_b16 v[234:235], v5 offset:15360
    ds_read_b64_tr_b16 v[236:237], v15 offset:14336
    ds_read_b64_tr_b16 v[238:239], v15 offset:15360
    s_waitcnt vmcnt(8)
    s_waitcnt lgkmcnt(6)
    v_mfma_f32_32x32x16_bf16 v[16:31], v[224:227], v[96:99], v[16:31]
    v_mfma_f32_32x32x16_bf16 v[32:47], v[224:227], v[100:103], v[32:47]
    s_waitcnt lgkmcnt(4)
    v_mfma_f32_32x32x16_bf16 v[48:63], v[228:231], v[96:99], v[48:63]
    v_mfma_f32_32x32x16_bf16 v[64:79], v[228:231], v[100:103], v[64:79]
    s_waitcnt lgkmcnt(2)
    v_mfma_f32_32x32x16_bf16 v[16:31], v[232:235], v[104:107], v[16:31]
    v_mfma_f32_32x32x16_bf16 v[32:47], v[232:235], v[108:111], v[32:47]
    s_waitcnt lgkmcnt(0)
    v_mfma_f32_32x32x16_bf16 v[48:63], v[236:239], v[104:107], v[48:63]
    v_mfma_f32_32x32x16_bf16 v[64:79], v[236:239], v[108:111], v[64:79]
    ds_read_b64_tr_b16 v[224:225], v5 offset:0
    ds_read_b64_tr_b16 v[226:227], v5 offset:1024
    ds_read_b64_tr_b16 v[228:229], v15 offset:0
    ds_read_b64_tr_b16 v[230:231], v15 offset:1024
    ds_read_b64_tr_b16 v[232:233], v5 offset:2048
    ds_read_b64_tr_b16 v[234:235], v5 offset:3072
    ds_read_b64_tr_b16 v[236:237], v15 offset:2048
    ds_read_b64_tr_b16 v[238:239], v15 offset:3072
    s_waitcnt vmcnt(4)
    s_waitcnt lgkmcnt(6)
    v_mfma_f32_32x32x16_bf16 v[16:31], v[224:227], v[112:115], v[16:31]
    v_mfma_f32_32x32x16_bf16 v[32:47], v[224:227], v[116:119], v[32:47]
    s_waitcnt lgkmcnt(4)
    v_mfma_f32_32x32x16_bf16 v[48:63], v[228:231], v[112:115], v[48:63]
    v_mfma_f32_32x32x16_bf16 v[64:79], v[228:231], v[116:119], v[64:79]
    s_waitcnt lgkmcnt(2)
    v_mfma_f32_32x32x16_bf16 v[16:31], v[232:235], v[120:123], v[16:31]
    v_mfma_f32_32x32x16_bf16 v[32:47], v[232:235], v[124:127], v[32:47]
    s_waitcnt lgkmcnt(0)
    v_mfma_f32_32x32x16_bf16 v[48:63], v[236:239], v[120:123], v[48:63]
    v_mfma_f32_32x32x16_bf16 v[64:79], v[236:239], v[124:127], v[64:79]
    ds_read_b64_tr_b16 v[224:225], v5 offset:4096
    ds_read_b64_tr_b16 v[226:227], v5 offset:5120
    ds_read_b64_tr_b16 v[228:229], v15 offset:4096
    ds_read_b64_tr_b16 v[230:231], v15 offset:5120
    ds_read_b64_tr_b16 v[232:233], v5 offset:6144
    ds_read_b64_tr_b16 v[234:235], v5 offset:7168
    ds_read_b64_tr_b16 v[236:237], v15 offset:6144
    ds_read_b64_tr_b16 v[238:239], v15 offset:7168
    s_waitcnt vmcnt(0)
    s_waitcnt lgkmcnt(6)
    v_mfma_f32_32x32x16_bf16 v[16:31], v[224:227], v[80:83], v[16:31]
    v_mfma_f32_32x32x16_bf16 v[32:47], v[224:227], v[84:87], v[32:47]
    s_waitcnt lgkmcnt(4)
    v_mfma_f32_32x32x16_bf16 v[48:63], v[228:231], v[80:83], v[48:63]
    v_mfma_f32_32x32x16_bf16 v[64:79], v[228:231], v[84:87], v[64:79]
    s_waitcnt lgkmcnt(2)
    v_mfma_f32_32x32x16_bf16 v[16:31], v[232:235], v[88:91], v[16:31]
    v_mfma_f32_32x32x16_bf16 v[32:47], v[232:235], v[92:95], v[32:47]
    s_waitcnt lgkmcnt(0)
    v_mfma_f32_32x32x16_bf16 v[48:63], v[236:239], v[88:91], v[48:63]
    v_mfma_f32_32x32x16_bf16 v[64:79], v[236:239], v[92:95], v[64:79]
    s_nop 11
    s_mov_b32 s49, s64
    v_add_u32 v13, s49, v3
    ds_write_b128 v13, v[16:19] offset:0
    ds_write_b128 v13, v[20:23] offset:1024
    ds_write_b128 v13, v[24:27] offset:2048
    ds_write_b128 v13, v[28:31] offset:3072
    ds_write_b128 v13, v[32:35] offset:4096
    ds_write_b128 v13, v[36:39] offset:5120
    ds_write_b128 v13, v[40:43] offset:6144
    ds_write_b128 v13, v[44:47] offset:7168
    ds_write_b128 v13, v[48:51] offset:8192
    ds_write_b128 v13, v[52:55] offset:9216
    ds_write_b128 v13, v[56:59] offset:10240
    ds_write_b128 v13, v[60:63] offset:11264
    ds_write_b128 v13, v[64:67] offset:12288
    ds_write_b128 v13, v[68:71] offset:13312
    ds_write_b128 v13, v[72:75] offset:14336
    ds_write_b128 v13, v[76:79] offset:15360
    s_branch L_s3_join
L_s3_D9:
    s_waitcnt vmcnt(13)
    ds_read_b64_tr_b16 v[128:129], v5 offset:0
    ds_read_b64_tr_b16 v[130:131], v5 offset:1024
    ds_read_b64_tr_b16 v[132:133], v15 offset:0
    ds_read_b64_tr_b16 v[134:135], v15 offset:1024
    ds_read_b64_tr_b16 v[136:137], v5 offset:2048
    ds_read_b64_tr_b16 v[138:139], v5 offset:3072
    ds_read_b64_tr_b16 v[140:141], v15 offset:2048
    ds_read_b64_tr_b16 v[142:143], v15 offset:3072
    s_waitcnt vmcnt(0)
    v_mov_b32 v252, 159244
    v_mov_b32 v253, 1
    s_mov_b64 exec, 1
    ds_add_rtn_u32 v254, v252, v253
    s_mov_b64 exec, -1
    s_waitcnt lgkmcnt(0)
    v_readfirstlane_b32 s92, v254
    s_nop 3
    s_cmp_lg_u32 s92, 7
    s_cbranch_scc1 L_arr_59
    v_mov_b32 v252, 159232
    ds_read_b64 v[248:249], v252
    s_waitcnt lgkmcnt(0)
    v_readfirstlane_b32 s90, v248
    v_readfirstlane_b32 s91, v249
    s_nop 3
    s_lshl_b32 s92, s94, 3
    s_add_u32 s92, s92, 25169920
    v_mov_b32 v248, s90
    v_mov_b32 v249, s91
    v_mov_b32 v255, s92
    s_mov_b64 exec, 1
    buffer_store_dwordx2 v[248:249], v255, s[96:99], 0 offen sc1
    s_mov_b64 exec, -1
L_arr_59:
    s_waitcnt lgkmcnt(0)
    s_add_u32 m0, s64, 0
    s_add_u32 s52, s65, 114688
    buffer_load_dwordx4 v240, s[24:27], s52 offen lds
    s_add_u32 m0, s64, 1024
    s_add_u32 s52, s65, 121856
    buffer_load_dwordx4 v240, s[24:27], s52 offen lds
    s_add_u32 m0, s64, 2048
    s_add_u32 s52, s65, 129024
    buffer_load_dwordx4 v240, s[24:27], s52 offen lds
    s_add_u32 m0, s64, 3072
    s_add_u32 s52, s65, 136192
    buffer_load_dwordx4 v240, s[24:27], s52 offen lds
    s_waitcnt vmcnt(13)
    ds_read_b64_tr_b16 v[144:145], v5 offset:4096
    ds_read_b64_tr_b16 v[146:147], v5 offset:5120
    ds_read_b64_tr_b16 v[148:149], v15 offset:4096
    ds_read_b64_tr_b16 v[150:151], v15 offset:5120
    ds_read_b64_tr_b16 v[152:153], v5 offset:6144
    ds_read_b64_tr_b16 v[154:155], v5 offset:7168
    ds_read_b64_tr_b16 v[156:157], v15 offset:6144
    ds_read_b64_tr_b16 v[158:159], v15 offset:7168
    s_waitcnt lgkmcnt(0)
    s_add_u32 m0, s64, 4096
    s_add_u32 s52, s65, 143360
    buffer_load_dwordx4 v240, s[24:27], s52 offen lds
    s_add_u32 m0, s64, 5120
    s_add_u32 s52, s65, 150528
    buffer_load_dwordx4 v240, s[24:27], s52 offen lds
    s_add_u32 m0, s64, 6144
    s_add_u32 s52, s65, 157696
    buffer_load_dwordx4 v240, s[24:27], s52 offen lds
    s_add_u32 m0, s64, 7168
    s_add_u32 s52, s65, 164864
    buffer_load_dwordx4 v240, s[24:27], s52 offen lds
    s_waitcnt vmcnt(13)
    ds_read_b64_tr_b16 v[160:161], v5 offset:8192
    ds_read_b64_tr_b16 v[162:163], v5 offset:9216
    ds_read_b64_tr_b16 v[164:165], v15 offset:8192
    ds_read_b64_tr_b16 v[166:167], v15 offset:9216
    ds_read_b64_tr_b16 v[168:169], v5 offset:10240
    ds_read_b64_tr_b16 v[170:171], v5 offset:11264
    ds_read_b64_tr_b16 v[172:173], v15 offset:10240
    ds_read_b64_tr_b16 v[174:175], v15 offset:11264
    s_waitcnt lgkmcnt(0)
    s_add_u32 m0, s64, 8192
    s_add_u32 s52, s65, 172032
    buffer_load_dwordx4 v240, s[24:27], s52 offen lds
    s_add_u32 m0, s64, 9216
    s_add_u32 s52, s65, 179200
    buffer_load_dwordx4 v240, s[24:27], s52 offen lds
    s_add_u32 m0, s64, 10240
    s_add_u32 s52, s65, 186368
    buffer_load_dwordx4 v240, s[24:27], s52 offen lds
    s_add_u32 m0, s64, 11264
    s_add_u32 s52, s65, 193536
    buffer_load_dwordx4 v240, s[24:27], s52 offen lds
    s_waitcnt vmcnt(13)
    ds_read_b64_tr_b16 v[176:177], v5 offset:12288
    ds_read_b64_tr_b16 v[178:179], v5 offset:13312
    ds_read_b64_tr_b16 v[180:181], v15 offset:12288
    ds_read_b64_tr_b16 v[182:183], v15 offset:13312
    ds_read_b64_tr_b16 v[184:185], v5 offset:14336
    ds_read_b64_tr_b16 v[186:187], v5 offset:15360
    ds_read_b64_tr_b16 v[188:189], v15 offset:14336
    ds_read_b64_tr_b16 v[190:191], v15 offset:15360
    s_waitcnt lgkmcnt(0)
    s_add_u32 m0, s64, 12288
    s_add_u32 s52, s65, 200704
    buffer_load_dwordx4 v240, s[24:27], s52 offen lds
    s_add_u32 m0, s64, 13312
    s_add_u32 s52, s65, 207872
    buffer_load_dwordx4 v240, s[24:27], s52 offen lds
    s_add_u32 m0, s64, 14336
    s_add_u32 s52, s65, 215040
    buffer_load_dwordx4 v240, s[24:27], s52 offen lds
    s_add_u32 m0, s64, 15360
    s_add_u32 s52, s65, 222208
    buffer_load_dwordx4 v240, s[24:27], s52 offen lds
    s_waitcnt vmcnt(12)
    ds_read_b64_tr_b16 v[192:193], v5 offset:0
    ds_read_b64_tr_b16 v[194:195], v5 offset:1024
    ds_read_b64_tr_b16 v[196:197], v15 offset:0
    ds_read_b64_tr_b16 v[198:199], v15 offset:1024
    ds_read_b64_tr_b16 v[200:201], v5 offset:2048
    ds_read_b64_tr_b16 v[202:203], v5 offset:3072
    ds_read_b64_tr_b16 v[204:205], v15 offset:2048
    ds_read_b64_tr_b16 v[206:207], v15 offset:3072
    s_waitcnt lgkmcnt(0)
    s_add_u32 m0, s64, 0
    s_add_u32 s52, s65, 229376
    buffer_load_dwordx4 v240, s[24:27], s52 offen lds
    s_add_u32 m0, s64, 1024
    s_add_u32 s52, s65, 236544
    buffer_load_dwordx4 v240, s[24:27], s52 offen lds
    s_add_u32 m0, s64, 2048
    s_add_u32 s52, s65, 243712
    buffer_load_dwordx4 v240, s[24:27], s52 offen lds
    s_add_u32 m0, s64, 3072
    s_add_u32 s52, s65, 250880
    buffer_load_dwordx4 v240, s[24:27], s52 offen lds
    s_waitcnt vmcnt(12)
    ds_read_b64_tr_b16 v[208:209], v5 offset:4096
    ds_read_b64_tr_b16 v[210:211], v5 offset:5120
    ds_read_b64_tr_b16 v[212:213], v15 offset:4096
    ds_read_b64_tr_b16 v[214:215], v15 offset:5120
    ds_read_b64_tr_b16 v[216:217], v5 offset:6144
    ds_read_b64_tr_b16 v[218:219], v5 offset:7168
    ds_read_b64_tr_b16 v[220:221], v15 offset:6144
    ds_read_b64_tr_b16 v[222:223], v15 offset:7168
    s_waitcnt lgkmcnt(0)
    v_mov_b32 v252, 159232
    ds_read_b64 v[248:249], v252
    s_waitcnt lgkmcnt(0)
    v_readfirstlane_b32 s90, v248
    v_readfirstlane_b32 s91, v249
    s_nop 3
    s_lshr_b32 s49, s61, 1
    s_lshl_b32 s49, s49, 7
    s_add_u32 s49, s49, 25167872
    s_lshl_b32 s50, s63, 5
    s_mul_i32 s51, s50, 9363
    s_lshr_b32 s51, s51, 20
    s_add_u32 s50, s50, 287
    s_mul_i32 s50, s50, 9363
    s_lshr_b32 s50, s50, 20
    v_add_u32 v255, s51, v1
    v_min_u32 v255, s50, v255
    v_lshlrev_b32 v255, 3, v255
    v_add_u32 v255, s49, v255
    s_mov_b32 s95, 0
    s_mov_b64 exec, 15
L_poll_60:
    buffer_load_dwordx2 v[252:253], v255, s[96:99], 0 offen sc1
    s_waitcnt vmcnt(0)
    v_cmp_ne_u64 vcc, s[90:91], v[252:253]
    s_nop 1
    s_cmp_eq_u64 vcc, 0
    s_cbranch_scc1 L_polld_61
    s_sleep 2
    s_add_u32 s95, s95, 1
    s_cmp_lt_u32 s95, 0x40000
    s_cbranch_scc1 L_poll_60
L_polld_61:
    s_mov_b64 exec, -1
    s_mul_i32 s51, s61, 224
    s_lshl_b32 s52, s63, 1
    s_add_u32 s51, s51, s52
    s_lshl_b32 s51, s51, 10
    s_add_u32 s51, s51, 6291456
    s_add_u32 s52, s51, 0
    buffer_load_dwordx4 v[80:83], v3, s[40:43], s52 offen sc1
    s_add_u32 s52, s51, 114688
    buffer_load_dwordx4 v[84:87], v3, s[40:43], s52 offen sc1
    s_add_u32 s52, s51, 1024
    buffer_load_dwordx4 v[88:91], v3, s[40:43], s52 offen sc1
    s_add_u32 s52, s51, 115712
    buffer_load_dwordx4 v[92:95], v3, s[40:43], s52 offen sc1
    s_add_u32 s52, s51, 2048
    buffer_load_dwordx4 v[96:99], v3, s[40:43], s52 offen sc1
    s_add_u32 s52, s51, 116736
    buffer_load_dwordx4 v[100:103], v3, s[40:43], s52 offen sc1
    s_add_u32 s52, s51, 3072
    buffer_load_dwordx4 v[104:107], v3, s[40:43], s52 offen sc1
    s_add_u32 s52, s51, 117760
    buffer_load_dwordx4 v[108:111], v3, s[40:43], s52 offen sc1
    s_add_u32 s52, s51, 4096
    buffer_load_dwordx4 v[112:115], v3, s[40:43], s52 offen sc1
    s_add_u32 s52, s51, 118784
    buffer_load_dwordx4 v[116:119], v3, s[40:43], s52 offen sc1
    s_add_u32 s52, s51, 5120
    buffer_load_dwordx4 v[120:123], v3, s[40:43], s52 offen sc1
    s_add_u32 s52, s51, 119808
    buffer_load_dwordx4 v[124:127], v3, s[40:43], s52 offen sc1
    s_waitcnt vmcnt(8)
    v_mfma_f32_32x32x16_bf16 v[16:31], v[128:131], v[80:83], 0
    v_mfma_f32_32x32x16_bf16 v[32:47], v[128:131], v[84:87], 0
    v_mfma_f32_32x32x16_bf16 v[48:63], v[132:135], v[80:83], 0
    v_mfma_f32_32x32x16_bf16 v[64:79], v[132:135], v[84:87], 0
    v_mfma_f32_32x32x16_bf16 v[16:31], v[136:139], v[88:91], v[16:31]
    v_mfma_f32_32x32x16_bf16 v[32:47], v[136:139], v[92:95], v[32:47]
    v_mfma_f32_32x32x16_bf16 v[48:63], v[140:143], v[88:91], v[48:63]
    v_mfma_f32_32x32x16_bf16 v[64:79], v[140:143], v[92:95], v[64:79]
    s_add_u32 s52, s51, 6144
    buffer_load_dwordx4 v[80:83], v3, s[40:43], s52 offen sc1
    s_add_u32 s52, s51, 120832
    buffer_load_dwordx4 v[84:87], v3, s[40:43], s52 offen sc1
    s_add_u32 s52, s51, 7168
    buffer_load_dwordx4 v[88:91], v3, s[40:43], s52 offen sc1
    s_add_u32 s52, s51, 121856
    buffer_load_dwordx4 v[92:95], v3, s[40:43], s52 offen sc1
    s_waitcnt vmcnt(8)
    v_mfma_f32_32x32x16_bf16 v[16:31], v[144:147], v[96:99], v[16:31]
    v_mfma_f32_32x32x16_bf16 v[32:47], v[144:147], v[100:103], v[32:47]
    v_mfma_f32_32x32x16_bf16 v[48:63], v[148:151], v[96:99], v[48:63]
    v_mfma_f32_32x32x16_bf16 v[64:79], v[148:151], v[100:103], v[64:79]
    v_mfma_f32_32x32x16_bf16 v[16:31], v[152:155], v[104:107], v[16:31]
    v_mfma_f32_32x32x16_bf16 v[32:47], v[152:155], v[108:111], v[32:47]
    v_mfma_f32_32x32x16_bf16 v[48:63], v[156:159], v[104:107], v[48:63]
    v_mfma_f32_32x32x16_bf16 v[64:79], v[156:159], v[108:111], v[64:79]
    s_add_u32 s52, s51, 8192
    buffer_load_dwordx4 v[96:99], v3, s[40:43], s52 offen sc1
    s_add_u32 s52, s51, 122880
    buffer_load_dwordx4 v[100:103], v3, s[40:43], s52 offen sc1
    s_add_u32 s52, s51, 9216
    buffer_load_dwordx4 v[104:107], v3, s[40:43], s52 offen sc1
    s_add_u32 s52, s51, 123904
    buffer_load_dwordx4 v[108:111], v3, s[40:43], s52 offen sc1
    s_waitcnt vmcnt(8)
    v_mfma_f32_32x32x16_bf16 v[16:31], v[160:163], v[112:115], v[16:31]
    v_mfma_f32_32x32x16_bf16 v[32:47], v[160:163], v[116:119], v[32:47]
    v_mfma_f32_32x32x16_bf16 v[48:63], v[164:167], v[112:115], v[48:63]
    v_mfma_f32_32x32x16_bf16 v[64:79], v[164:167], v[116:119], v[64:79]
    v_mfma_f32_32x32x16_bf16 v[16:31], v[168:171], v[120:123], v[16:31]
    v_mfma_f32_32x32x16_bf16 v[32:47], v[168:171], v[124:127], v[32:47]
    v_mfma_f32_32x32x16_bf16 v[48:63], v[172:175], v[120:123], v[48:63]
    v_mfma_f32_32x32x16_bf16 v[64:79], v[172:175], v[124:127], v[64:79]
    s_add_u32 s52, s51, 10240
    buffer_load_dwordx4 v[112:115], v3, s[40:43], s52 offen sc1
    s_add_u32 s52, s51, 124928
    buffer_load_dwordx4 v[116:119], v3, s[40:43], s52 offen sc1
    s_add_u32 s52, s51, 11264
    buffer_load_dwordx4 v[120:123], v3, s[40:43], s52 offen sc1
    s_add_u32 s52, s51, 125952
    buffer_load_dwordx4 v[124:127], v3, s[40:43], s52 offen sc1
    s_waitcnt vmcnt(8)
    v_mfma_f32_32x32x16_bf16 v[16:31], v[176:179], v[80:83], v[16:31]
    v_mfma_f32_32x32x16_bf16 v[32:47], v[176:179], v[84:87], v[32:47]
    v_mfma_f32_32x32x16_bf16 v[48:63], v[180:183], v[80:83], v[48:63]
    v_mfma_f32_32x32x16_bf16 v[64:79], v[180:183], v[84:87], v[64:79]
    v_mfma_f32_32x32x16_bf16 v[16:31], v[184:187], v[88:91], v[16:31]
    v_mfma_f32_32x32x16_bf16 v[32:47], v[184:187], v[92:95], v[32:47]
    v_mfma_f32_32x32x16_bf16 v[48:63], v[188:191], v[88:91], v[48:63]
    v_mfma_f32_32x32x16_bf16 v[64:79], v[188:191], v[92:95], v[64:79]
    s_add_u32 s52, s51, 12288
    buffer_load_dwordx4 v[80:83], v3, s[40:43], s52 offen sc1
    s_add_u32 s52, s51, 126976
    buffer_load_dwordx4 v[84:87], v3, s[40:43], s52 offen sc1
    s_add_u32 s52, s51, 13312
    buffer_load_dwordx4 v[88:91], v3, s[40:43], s52 offen sc1
    s_add_u32 s52, s51, 128000
    buffer_load_dwordx4 v[92:95], v3, s[40:43], s52 offen sc1
    s_waitcnt vmcnt(8)
    v_mfma_f32_32x32x16_bf16 v[16:31], v[192:195], v[96:99], v[16:31]
    v_mfma_f32_32x32x16_bf16 v[32:47], v[192:195], v[100:103], v[32:47]
    v_mfma_f32_32x32x16_bf16 v[48:63], v[196:199], v[96:99], v[48:63]
    v_mfma_f32_32x32x16_bf16 v[64:79], v[196:199], v[100:103], v[64:79]
    v_mfma_f32_32x32x16_bf16 v[16:31], v[200:203], v[104:107], v[16:31]
    v_mfma_f32_32x32x16_bf16 v[32:47], v[200:203], v[108:111], v[32:47]
    v_mfma_f32_32x32x16_bf16 v[48:63], v[204:207], v[104:107], v[48:63]
    v_mfma_f32_32x32x16_bf16 v[64:79], v[204:207], v[108:111], v[64:79]
    s_add_u32 s52, s51, 14336
    buffer_load_dwordx4 v[96:99], v3, s[40:43], s52 offen sc1
    s_add_u32 s52, s51, 129024
    buffer_load_dwordx4 v[100:103], v3, s[40:43], s52 offen sc1
    s_add_u32 s52, s51, 15360
    buffer_load_dwordx4 v[104:107], v3, s[40:43], s52 offen sc1
    s_add_u32 s52, s51, 130048
    buffer_load_dwordx4 v[108:111], v3, s[40:43], s52 offen sc1
    s_waitcnt vmcnt(8)
    v_mfma_f32_32x32x16_bf16 v[16:31], v[208:211], v[112:115], v[16:31]
    v_mfma_f32_32x32x16_bf16 v[32:47], v[208:211], v[116:119], v[32:47]
    v_mfma_f32_32x32x16_bf16 v[48:63], v[212:215], v[112:115], v[48:63]
    v_mfma_f32_32x32x16_bf16 v[64:79], v[212:215], v[116:119], v[64:79]
    v_mfma_f32_32x32x16_bf16 v[16:31], v[216:219], v[120:123], v[16:31]
    v_mfma_f32_32x32x16_bf16 v[32:47], v[216:219], v[124:127], v[32:47]
    v_mfma_f32_32x32x16_bf16 v[48:63], v[220:223], v[120:123], v[48:63]
    v_mfma_f32_32x32x16_bf16 v[64:79], v[220:223], v[124:127], v[64:79]
    s_add_u32 s52, s51, 16384
    buffer_load_dwordx4 v[112:115], v3, s[40:43], s52 offen sc1
    s_add_u32 s52, s51, 131072
    buffer_load_dwordx4 v[116:119], v3, s[40:43], s52 offen sc1
    s_add_u32 s52, s51, 17408
    buffer_load_dwordx4 v[120:123], v3, s[40:43], s52 offen sc1
    s_add_u32 s52, s51, 132096
    buffer_load_dwordx4 v[124:127], v3, s[40:43], s52 offen sc1
    ds_read_b64_tr_b16 v[224:225], v5 offset:8192
    ds_read_b64_tr_b16 v[226:227], v5 offset:9216
    ds_read_b64_tr_b16 v[228:229], v15 offset:8192
    ds_read_b64_tr_b16 v[230:231], v15 offset:9216
    ds_read_b64_tr_b16 v[232:233], v5 offset:10240
    ds_read_b64_tr_b16 v[234:235], v5 offset:11264
    ds_read_b64_tr_b16 v[236:237], v15 offset:10240
    ds_read_b64_tr_b16 v[238:239], v15 offset:11264
    s_waitcnt vmcnt(8)
    s_waitcnt lgkmcnt(6)
    v_mfma_f32_32x32x16_bf16 v[16:31], v[224:227], v[80:83], v[16:31]
    v_mfma_f32_32x32x16_bf16 v[32:47], v[224:227], v[84:87], v[32:47]
    s_waitcnt lgkmcnt(4)
    v_mfma_f32_32x32x16_bf16 v[48:63], v[228:231], v[80:83], v[48:63]
    v_mfma_f32_32x32x16_bf16 v[64:79], v[228:231], v[84:87], v[64:79]
    s_waitcnt lgkmcnt(2)
    v_mfma_f32_32x32x16_bf16 v[16:31], v[232:235], v[88:91], v[16:31]
    v_mfma_f32_32x32x16_bf16 v[32:47], v[232:235], v[92:95], v[32:47]
    s_waitcnt lgkmcnt(0)
    v_mfma_f32_32x32x16_bf16 v[48:63], v[236:239], v[88:91], v[48:63]
    v_mfma_f32_32x32x16_bf16 v[64:79], v[236:239], v[92:95], v[64:79]
    ds_read_b64_tr_b16 v[224:225], v5 offset:12288
    ds_read_b64_tr_b16 v[226:227], v5 offset:13312
    ds_read_b64_tr_b16 v[228:229], v15 offset:12288
    ds_read_b64_tr_b16 v[230:231], v15 offset:13312
    ds_read_b64_tr_b16 v[232:233], v5 offset:14336
    ds_read_b64_tr_b16 v[234:235], v5 offset:15360
    ds_read_b64_tr_b16 v[236:237], v15 offset:14336
    ds_read_b64_tr_b16 v[238:239], v15 offset:15360
    s_waitcnt vmcnt(4)
    s_waitcnt lgkmcnt(6)
    v_mfma_f32_32x32x16_bf16 v[16:31], v[224:227], v[96:99], v[16:31]
    v_mfma_f32_32x32x16_bf16 v[32:47], v[224:227], v[100:103], v[32:47]
    s_waitcnt lgkmcnt(4)
    v_mfma_f32_32x32x16_bf16 v[48:63], v[228:231], v[96:99], v[48:63]
    v_mfma_f32_32x32x16_bf16 v[64:79], v[228:231], v[100:103], v[64:79]
    s_waitcnt lgkmcnt(2)
    v_mfma_f32_32x32x16_bf16 v[16:31], v[232:235], v[104:107], v[16:31]
    v_mfma_f32_32x32x16_bf16 v[32:47], v[232:235], v[108:111], v[32:47]
    s_waitcnt lgkmcnt(0)
    v_mfma_f32_32x32x16_bf16 v[48:63], v[236:239], v[104:107], v[48:63]
    v_mfma_f32_32x32x16_bf16 v[64:79], v[236:239], v[108:111], v[64:79]
    ds_read_b64_tr_b16 v[224:225], v5 offset:0
    ds_read_b64_tr_b16 v[226:227], v5 offset:1024
    ds_read_b64_tr_b16 v[228:229], v15 offset:0
    ds_read_b64_tr_b16 v[230:231], v15 offset:1024
    ds_read_b64_tr_b16 v[232:233], v5 offset:2048
    ds_read_b64_tr_b16 v[234:235], v5 offset:3072
    ds_read_b64_tr_b16 v[236:237], v15 offset:2048
    ds_read_b64_tr_b16 v[238:239], v15 offset:3072
    s_waitcnt vmcnt(0)
    s_waitcnt lgkmcnt(6)
    v_mfma_f32_32x32x16_bf16 v[16:31], v[224:227], v[112:115], v[16:31]
    v_mfma_f32_32x32x16_bf16 v[32:47], v[224:227], v[116:119], v[32:47]
    s_waitcnt lgkmcnt(4)
    v_mfma_f32_32x32x16_bf16 v[48:63], v[228:231], v[112:115], v[48:63]
    v_mfma_f32_32x32x16_bf16 v[64:79], v[228:231], v[116:119], v[64:79]
    s_waitcnt lgkmcnt(2)
    v_mfma_f32_32x32x16_bf16 v[16:31], v[232:235], v[120:123], v[16:31]
    v_mfma_f32_32x32x16_bf16 v[32:47], v[232:235], v[124:127], v[32:47]
    s_waitcnt lgkmcnt(0)
    v_mfma_f32_32x32x16_bf16 v[48:63], v[236:239], v[120:123], v[48:63]
    v_mfma_f32_32x32x16_bf16 v[64:79], v[236:239], v[124:127], v[64:79]
    s_nop 11
    s_mov_b32 s49, s64
    v_add_u32 v13, s49, v3
    ds_write_b128 v13, v[16:19] offset:0
    ds_write_b128 v13, v[20:23] offset:1024
    ds_write_b128 v13, v[24:27] offset:2048
    ds_write_b128 v13, v[28:31] offset:3072
    ds_write_b128 v13, v[32:35] offset:4096
    ds_write_b128 v13, v[36:39] offset:5120
    ds_write_b128 v13, v[40:43] offset:6144
    ds_write_b128 v13, v[44:47] offset:7168
    ds_write_b128 v13, v[48:51] offset:8192
    ds_write_b128 v13, v[52:55] offset:9216
    ds_write_b128 v13, v[56:59] offset:10240
    ds_write_b128 v13, v[60:63] offset:11264
    ds_write_b128 v13, v[64:67] offset:12288
    ds_write_b128 v13, v[68:71] offset:13312
    ds_write_b128 v13, v[72:75] offset:14336
    ds_write_b128 v13, v[76:79] offset:15360
    s_branch L_s3_join
L_s3_E:
    v_lshl_add_u32 v5, v2, 9, v5
    v_xor_b32 v15, 64, v5
    s_waitcnt vmcnt(1)
    ds_read_b64_tr_b16 v[128:129], v5 offset:0
    ds_read_b64_tr_b16 v[130:131], v5 offset:512
    ds_read_b64_tr_b16 v[132:133], v15 offset:0
    ds_read_b64_tr_b16 v[134:135], v15 offset:512
    ds_read_b64_tr_b16 v[136:137], v5 offset:2048
    ds_read_b64_tr_b16 v[138:139], v5 offset:2560
    ds_read_b64_tr_b16 v[140:141], v15 offset:2048
    ds_read_b64_tr_b16 v[142:143], v15 offset:2560
    s_waitcnt vmcnt(0)
    v_mov_b32 v252, 159244
    v_mov_b32 v253, 1
    s_mov_b64 exec, 1
    ds_add_rtn_u32 v254, v252, v253
    s_mov_b64 exec, -1
    s_waitcnt lgkmcnt(0)
    v_readfirstlane_b32 s92, v254
    s_nop 3
    s_cmp_lg_u32 s92, 7
    s_cbranch_scc1 L_arr_62
    v_mov_b32 v252, 159232
    ds_read_b64 v[248:249], v252
    s_waitcnt lgkmcnt(0)
    v_readfirstlane_b32 s90, v248
    v_readfirstlane_b32 s91, v249
    s_nop 3
    s_lshl_b32 s92, s94, 3
    s_add_u32 s92, s92, 25169920
    v_mov_b32 v248, s90
    v_mov_b32 v249, s91
    v_mov_b32 v255, s92
    s_mov_b64 exec, 1
    buffer_store_dwordx2 v[248:249], v255, s[96:99], 0 offen sc1
    s_mov_b64 exec, -1
L_arr_62:
    s_waitcnt lgkmcnt(0)
    s_add_u32 m0, s64, 0
    s_add_u32 s52, s65, 25088
    buffer_load_dwordx4 v240, s[28:31], s52 offen lds
    s_add_u32 m0, s64, 1024
    s_add_u32 s52, s65, 32256
    buffer_load_dwordx4 v240, s[28:31], s52 offen lds
    s_add_u32 m0, s64, 2048
    s_add_u32 s52, s65, 39424
    buffer_load_dwordx4 v240, s[28:31], s52 offen lds
    s_add_u32 m0, s64, 3072
    s_add_u32 s52, s65, 46592
    buffer_load_dwordx4 v240, s[28:31], s52 offen lds
    s_waitcnt vmcnt(0)
    ds_read_b64_tr_b16 v[144:145], v5 offset:0
    ds_read_b64_tr_b16 v[146:147], v5 offset:512
    ds_read_b64_tr_b16 v[148:149], v15 offset:0
    ds_read_b64_tr_b16 v[150:151], v15 offset:512
    ds_read_b64_tr_b16 v[152:153], v5 offset:2048
    ds_read_b64_tr_b16 v[154:155], v5 offset:2560
    ds_read_b64_tr_b16 v[156:157], v15 offset:2048
    ds_read_b64_tr_b16 v[158:159], v15 offset:2560
    s_waitcnt lgkmcnt(0)
    s_add_u32 m0, s64, 0
    s_add_u32 s52, s65, 50176
    buffer_load_dwordx4 v240, s[28:31], s52 offen lds
    s_add_u32 m0, s64, 1024
    s_add_u32 s52, s65, 57344
    buffer_load_dwordx4 v240, s[28:31], s52 offen lds
    s_add_u32 m0, s64, 2048
    s_add_u32 s52, s65, 64512
    buffer_load_dwordx4 v240, s[28:31], s52 offen lds
    s_add_u32 m0, s64, 3072
    s_add_u32 s52, s65, 71680
    buffer_load_dwordx4 v240, s[28:31], s52 offen lds
    s_waitcnt vmcnt(0)
    ds_read_b64_tr_b16 v[160:161], v5 offset:0
    ds_read_b64_tr_b16 v[162:163], v5 offset:512
    ds_read_b64_tr_b16 v[164:165], v15 offset:0
    ds_read_b64_tr_b16 v[166:167], v15 offset:512
    ds_read_b64_tr_b16 v[168:169], v5 offset:2048
    ds_read_b64_tr_b16 v[170:171], v5 offset:2560
    ds_read_b64_tr_b16 v[172:173], v15 offset:2048
    ds_read_b64_tr_b16 v[174:175], v15 offset:2560
    s_waitcnt lgkmcnt(0)
    s_add_u32 m0, s64, 0
    s_add_u32 s52, s65, 75264
    buffer_load_dwordx4 v240, s[28:31], s52 offen lds
    s_add_u32 m0, s64, 1024
    s_add_u32 s52, s65, 82432
    buffer_load_dwordx4 v240, s[28:31], s52 offen lds
    s_add_u32 m0, s64, 2048
    s_add_u32 s52, s65, 89600
    buffer_load_dwordx4 v240, s[28:31], s52 offen lds
    s_add_u32 m0, s64, 3072
    s_add_u32 s52, s65, 96768
    buffer_load_dwordx4 v240, s[28:31], s52 offen lds
    s_waitcnt vmcnt(0)
    ds_read_b64_tr_b16 v[176:177], v5 offset:0
    ds_read_b64_tr_b16 v[178:179], v5 offset:512
    ds_read_b64_tr_b16 v[180:181], v15 offset:0
    ds_read_b64_tr_b16 v[182:183], v15 offset:512
    ds_read_b64_tr_b16 v[184:185], v5 offset:2048
    ds_read_b64_tr_b16 v[186:187], v5 offset:2560
    ds_read_b64_tr_b16 v[188:189], v15 offset:2048
    ds_read_b64_tr_b16 v[190:191], v15 offset:2560
    s_waitcnt lgkmcnt(0)
    s_add_u32 m0, s64, 0
    s_add_u32 s52, s65, 100352
    buffer_load_dwordx4 v240, s[28:31], s52 offen lds
    s_add_u32 m0, s64, 1024
    s_add_u32 s52, s65, 107520
    buffer_load_dwordx4 v240, s[28:31], s52 offen lds
    s_add_u32 m0, s64, 2048
    s_add_u32 s52, s65, 114688
    buffer_load_dwordx4 v240, s[28:31], s52 offen lds
    s_add_u32 m0, s64, 3072
    s_add_u32 s52, s65, 121856
    buffer_load_dwordx4 v240, s[28:31], s52 offen lds
    s_waitcnt vmcnt(0)
    ds_read_b64_tr_b16 v[192:193], v5 offset:0
    ds_read_b64_tr_b16 v[194:195], v5 offset:512
    ds_read_b64_tr_b16 v[196:197], v15 offset:0
    ds_read_b64_tr_b16 v[198:199], v15 offset:512
    ds_read_b64_tr_b16 v[200:201], v5 offset:2048
    ds_read_b64_tr_b16 v[202:203], v5 offset:2560
    ds_read_b64_tr_b16 v[204:205], v15 offset:2048
    ds_read_b64_tr_b16 v[206:207], v15 offset:2560
    s_waitcnt lgkmcnt(0)
    s_add_u32 m0, s64, 0
    s_add_u32 s52, s65, 125440
    buffer_load_dwordx4 v240, s[28:31], s52 offen lds
    s_add_u32 m0, s64, 1024
    s_add_u32 s52, s65, 132608
    buffer_load_dwordx4 v240, s[28:31], s52 offen lds
    s_add_u32 m0, s64, 2048
    s_add_u32 s52, s65, 139776
    buffer_load_dwordx4 v240, s[28:31], s52 offen lds
    s_add_u32 m0, s64, 3072
    s_add_u32 s52, s65, 146944
    buffer_load_dwordx4 v240, s[28:31], s52 offen lds
    s_waitcnt vmcnt(0)
    ds_read_b64_tr_b16 v[208:209], v5 offset:0
    ds_read_b64_tr_b16 v[210:211], v5 offset:512
    ds_read_b64_tr_b16 v[212:213], v15 offset:0
    ds_read_b64_tr_b16 v[214:215], v15 offset:512
    ds_read_b64_tr_b16 v[216:217], v5 offset:2048
    ds_read_b64_tr_b16 v[218:219], v5 offset:2560
    ds_read_b64_tr_b16 v[220:221], v15 offset:2048
    ds_read_b64_tr_b16 v[222:223], v15 offset:2560
    s_waitcnt lgkmcnt(0)
    s_add_u32 m0, s64, 0
    s_add_u32 s52, s65, 150528
    buffer_load_dwordx4 v240, s[28:31], s52 offen lds
    s_add_u32 m0, s64, 1024
    s_add_u32 s52, s65, 157696
    buffer_load_dwordx4 v240, s[28:31], s52 offen lds
    s_add_u32 m0, s64, 2048
    s_add_u32 s52, s65, 164864
    buffer_load_dwordx4 v240, s[28:31], s52 offen lds
    s_add_u32 m0, s64, 3072
    s_add_u32 s52, s65, 172032
    buffer_load_dwordx4 v240, s[28:31], s52 offen lds
    s_waitcnt vmcnt(0)
    ds_read_b64_tr_b16 v[224:225], v5 offset:0
    ds_read_b64_tr_b16 v[226:227], v5 offset:512
    ds_read_b64_tr_b16 v[228:229], v15 offset:0
    ds_read_b64_tr_b16 v[230:231], v15 offset:512
    ds_read_b64_tr_b16 v[232:233], v5 offset:2048
    ds_read_b64_tr_b16 v[234:235], v5 offset:2560
    ds_read_b64_tr_b16 v[236:237], v15 offset:2048
    ds_read_b64_tr_b16 v[238:239], v15 offset:2560
    s_waitcnt lgkmcnt(0)
    s_add_u32 m0, s64, 0
    s_add_u32 s52, s65, 175616
    buffer_load_dwordx4 v240, s[28:31], s52 offen lds
    s_add_u32 m0, s64, 1024
    s_add_u32 s52, s65, 182784
    buffer_load_dwordx4 v240, s[28:31], s52 offen lds
    s_add_u32 m0, s64, 2048
    s_add_u32 s52, s65, 189952
    buffer_load_dwordx4 v240, s[28:31], s52 offen lds
    s_add_u32 m0, s64, 3072
    s_add_u32 s52, s65, 197120
    buffer_load_dwordx4 v240, s[28:31], s52 offen lds
    v_mov_b32 v252, 159232
    ds_read_b64 v[248:249], v252
    s_waitcnt lgkmcnt(0)
    v_readfirstlane_b32 s90, v248
    v_readfirstlane_b32 s91, v249
    s_nop 3
    s_lshr_b32 s49, s61, 1
    s_lshl_b32 s49, s49, 7
    s_add_u32 s49, s49, 25169920
    v_add_u32 v255, s63, v1
    v_lshlrev_b32 v255, 3, v255
    v_add_u32 v255, s49, v255
    s_mov_b32 s95, 0
    s_mov_b64 exec, 255
L_poll_63:
    buffer_load_dwordx2 v[252:253], v255, s[96:99], 0 offen sc1
    s_waitcnt vmcnt(0)
    v_cmp_ne_u64 vcc, s[90:91], v[252:253]
    s_nop 1
    s_cmp_eq_u64 vcc, 0
    s_cbranch_scc1 L_polld_64
    s_sleep 2
    s_add_u32 s95, s95, 1
    s_cmp_lt_u32 s95, 0x40000
    s_cbranch_scc1 L_poll_63
L_polld_64:
    s_mov_b64 exec, -1
    s_lshl_b32 s51, s61, 6
    s_add_u32 s51, s51, s63
    s_lshl_b32 s51, s51, 10
    s_add_u32 s51, s51, 14680064
    s_add_u32 s52, s51, 0
    buffer_load_dwordx4 v[80:83], v6, s[40:43], s52 offen sc1
    s_add_u32 s52, s51, 32768
    buffer_load_dwordx4 v[84:87], v6, s[40:43], s52 offen sc1
    s_add_u32 s52, s51, 512
    buffer_load_dwordx4 v[88:91], v6, s[40:43], s52 offen sc1
    s_add_u32 s52, s51, 33280
    buffer_load_dwordx4 v[92:95], v6, s[40:43], s52 offen sc1
    s_add_u32 s52, s51, 1024
    buffer_load_dwordx4 v[96:99], v6, s[40:43], s52 offen sc1
    s_add_u32 s52, s51, 33792
    buffer_load_dwordx4 v[100:103], v6, s[40:43], s52 offen sc1
    s_add_u32 s52, s51, 1536
    buffer_load_dwordx4 v[104:107], v6, s[40:43], s52 offen sc1
    s_add_u32 s52, s51, 34304
    buffer_load_dwordx4 v[108:111], v6, s[40:43], s52 offen sc1
    s_add_u32 s52, s51, 2048
    buffer_load_dwordx4 v[112:115], v6, s[40:43], s52 offen sc1
    s_add_u32 s52, s51, 34816
    buffer_load_dwordx4 v[116:119], v6, s[40:43], s52 offen sc1
    s_add_u32 s52, s51, 2560
    buffer_load_dwordx4 v[120:123], v6, s[40:43], s52 offen sc1
    s_add_u32 s52, s51, 35328
    buffer_load_dwordx4 v[124:127], v6, s[40:43], s52 offen sc1
    s_waitcnt vmcnt(8)
    v_mfma_f32_32x32x16_bf16 v[16:31], v[128:131], v[80:83], 0
    v_mfma_f32_32x32x16_bf16 v[32:47], v[128:131], v[84:87], 0
    v_mfma_f32_32x32x16_bf16 v[48:63], v[132:135], v[80:83], 0
    v_mfma_f32_32x32x16_bf16 v[64:79], v[132:135], v[84:87], 0
    v_mfma_f32_32x32x16_bf16 v[16:31], v[136:139], v[88:91], v[16:31]
    v_mfma_f32_32x32x16_bf16 v[32:47], v[136:139], v[92:95], v[32:47]
    v_mfma_f32_32x32x16_bf16 v[48:63], v[140:143], v[88:91], v[48:63]
    v_mfma_f32_32x32x16_bf16 v[64:79], v[140:143], v[92:95], v[64:79]
    s_add_u32 s52, s51, 3072
    buffer_load_dwordx4 v[80:83], v6, s[40:43], s52 offen sc1
    s_add_u32 s52, s51, 35840
    buffer_load_dwordx4 v[84:87], v6, s[40:43], s52 offen sc1
    s_add_u32 s52, s51, 3584
    buffer_load_dwordx4 v[88:91], v6, s[40:43], s52 offen sc1
    s_add_u32 s52, s51, 36352
    buffer_load_dwordx4 v[92:95], v6, s[40:43], s52 offen sc1
    s_waitcnt vmcnt(8)
    v_mfma_f32_32x32x16_bf16 v[16:31], v[144:147], v[96:99], v[16:31]
    v_mfma_f32_32x32x16_bf16 v[32:47], v[144:147], v[100:103], v[32:47]
    v_mfma_f32_32x32x16_bf16 v[48:63], v[148:151], v[96:99], v[48:63]
    v_mfma_f32_32x32x16_bf16 v[64:79], v[148:151], v[100:103], v[64:79]
    v_mfma_f32_32x32x16_bf16 v[16:31], v[152:155], v[104:107], v[16:31]
    v_mfma_f32_32x32x16_bf16 v[32:47], v[152:155], v[108:111], v[32:47]
    v_mfma_f32_32x32x16_bf16 v[48:63], v[156:159], v[104:107], v[48:63]
    v_mfma_f32_32x32x16_bf16 v[64:79], v[156:159], v[108:111], v[64:79]
    s_add_u32 s52, s51, 4096
    buffer_load_dwordx4 v[96:99], v6, s[40:43], s52 offen sc1
    s_add_u32 s52, s51, 36864
    buffer_load_dwordx4 v[100:103], v6, s[40:43], s52 offen sc1
    s_add_u32 s52, s51, 4608
    buffer_load_dwordx4 v[104:107], v6, s[40:43], s52 offen sc1
    s_add_u32 s52, s51, 37376
    buffer_load_dwordx4 v[108:111], v6, s[40:43], s52 offen sc1
    s_waitcnt vmcnt(8)
    v_mfma_f32_32x32x16_bf16 v[16:31], v[160:163], v[112:115], v[16:31]
    v_mfma_f32_32x32x16_bf16 v[32:47], v[160:163], v[116:119], v[32:47]
    v_mfma_f32_32x32x16_bf16 v[48:63], v[164:167], v[112:115], v[48:63]
    v_mfma_f32_32x32x16_bf16 v[64:79], v[164:167], v[116:119], v[64:79]
    v_mfma_f32_32x32x16_bf16 v[16:31], v[168:171], v[120:123], v[16:31]
    v_mfma_f32_32x32x16_bf16 v[32:47], v[168:171], v[124:127], v[32:47]
    v_mfma_f32_32x32x16_bf16 v[48:63], v[172:175], v[120:123], v[48:63]
    v_mfma_f32_32x32x16_bf16 v[64:79], v[172:175], v[124:127], v[64:79]
    s_add_u32 s52, s51, 5120
    buffer_load_dwordx4 v[112:115], v6, s[40:43], s52 offen sc1
    s_add_u32 s52, s51, 37888
    buffer_load_dwordx4 v[116:119], v6, s[40:43], s52 offen sc1
    s_add_u32 s52, s51, 5632
    buffer_load_dwordx4 v[120:123], v6, s[40:43], s52 offen sc1
    s_add_u32 s52, s51, 38400
    buffer_load_dwordx4 v[124:127], v6, s[40:43], s52 offen sc1
    s_waitcnt vmcnt(8)
    v_mfma_f32_32x32x16_bf16 v[16:31], v[176:179], v[80:83], v[16:31]
    v_mfma_f32_32x32x16_bf16 v[32:47], v[176:179], v[84:87], v[32:47]
    v_mfma_f32_32x32x16_bf16 v[48:63], v[180:183], v[80:83], v[48:63]
    v_mfma_f32_32x32x16_bf16 v[64:79], v[180:183], v[84:87], v[64:79]
    v_mfma_f32_32x32x16_bf16 v[16:31], v[184:187], v[88:91], v[16:31]
    v_mfma_f32_32x32x16_bf16 v[32:47], v[184:187], v[92:95], v[32:47]
    v_mfma_f32_32x32x16_bf16 v[48:63], v[188:191], v[88:91], v[48:63]
    v_mfma_f32_32x32x16_bf16 v[64:79], v[188:191], v[92:95], v[64:79]
    s_add_u32 s52, s51, 6144
    buffer_load_dwordx4 v[80:83], v6, s[40:43], s52 offen sc1
    s_add_u32 s52, s51, 38912
    buffer_load_dwordx4 v[84:87], v6, s[40:43], s52 offen sc1
    s_add_u32 s52, s51, 6656
    buffer_load_dwordx4 v[88:91], v6, s[40:43], s52 offen sc1
    s_add_u32 s52, s51, 39424
    buffer_load_dwordx4 v[92:95], v6, s[40:43], s52 offen sc1
    s_waitcnt vmcnt(8)
    v_mfma_f32_32x32x16_bf16 v[16:31], v[192:195], v[96:99], v[16:31]
    v_mfma_f32_32x32x16_bf16 v[32:47], v[192:195], v[100:103], v[32:47]
    v_mfma_f32_32x32x16_bf16 v[48:63], v[196:199], v[96:99], v[48:63]
    v_mfma_f32_32x32x16_bf16 v[64:79], v[196:199], v[100:103], v[64:79]
    v_mfma_f32_32x32x16_bf16 v[16:31], v[200:203], v[104:107], v[16:31]
    v_mfma_f32_32x32x16_bf16 v[32:47], v[200:203], v[108:111], v[32:47]
    v_mfma_f32_32x32x16_bf16 v[48:63], v[204:207], v[104:107], v[48:63]
    v_mfma_f32_32x32x16_bf16 v[64:79], v[204:207], v[108:111], v[64:79]
    s_add_u32 s52, s51, 7168
    buffer_load_dwordx4 v[96:99], v6, s[40:43], s52 offen sc1
    s_add_u32 s52, s51, 39936
    buffer_load_dwordx4 v[100:103], v6, s[40:43], s52 offen sc1
    s_add_u32 s52, s51, 7680
    buffer_load_dwordx4 v[104:107], v6, s[40:43], s52 offen sc1
    s_add_u32 s52, s51, 40448
    buffer_load_dwordx4 v[108:111], v6, s[40:43], s52 offen sc1
    s_waitcnt vmcnt(8)
    v_mfma_f32_32x32x16_bf16 v[16:31], v[208:211], v[112:115], v[16:31]
    v_mfma_f32_32x32x16_bf16 v[32:47], v[208:211], v[116:119], v[32:47]
    v_mfma_f32_32x32x16_bf16 v[48:63], v[212:215], v[112:115], v[48:63]
    v_mfma_f32_32x32x16_bf16 v[64:79], v[212:215], v[116:119], v[64:79]
    v_mfma_f32_32x32x16_bf16 v[16:31], v[216:219], v[120:123], v[16:31]
    v_mfma_f32_32x32x16_bf16 v[32:47], v[216:219], v[124:127], v[32:47]
    v_mfma_f32_32x32x16_bf16 v[48:63], v[220:223], v[120:123], v[48:63]
    v_mfma_f32_32x32x16_bf16 v[64:79], v[220:223], v[124:127], v[64:79]
    s_waitcnt vmcnt(4)
    v_mfma_f32_32x32x16_bf16 v[16:31], v[224:227], v[80:83], v[16:31]
    v_mfma_f32_32x32x16_bf16 v[32:47], v[224:227], v[84:87], v[32:47]
    v_mfma_f32_32x32x16_bf16 v[48:63], v[228:231], v[80:83], v[48:63]
    v_mfma_f32_32x32x16_bf16 v[64:79], v[228:231], v[84:87], v[64:79]
    v_mfma_f32_32x32x16_bf16 v[16:31], v[232:235], v[88:91], v[16:31]
    v_mfma_f32_32x32x16_bf16 v[32:47], v[232:235], v[92:95], v[32:47]
    v_mfma_f32_32x32x16_bf16 v[48:63], v[236:239], v[88:91], v[48:63]
    v_mfma_f32_32x32x16_bf16 v[64:79], v[236:239], v[92:95], v[64:79]
    ds_read_b64_tr_b16 v[128:129], v5 offset:0
    ds_read_b64_tr_b16 v[130:131], v5 offset:512
    ds_read_b64_tr_b16 v[132:133], v15 offset:0
    ds_read_b64_tr_b16 v[134:135], v15 offset:512
    ds_read_b64_tr_b16 v[136:137], v5 offset:2048
    ds_read_b64_tr_b16 v[138:139], v5 offset:2560
    ds_read_b64_tr_b16 v[140:141], v15 offset:2048
    ds_read_b64_tr_b16 v[142:143], v15 offset:2560
    s_waitcnt vmcnt(0)
    s_waitcnt lgkmcnt(6)
    v_mfma_f32_32x32x16_bf16 v[16:31], v[128:131], v[96:99], v[16:31]
    v_mfma_f32_32x32x16_bf16 v[32:47], v[128:131], v[100:103], v[32:47]
    s_waitcnt lgkmcnt(4)
    v_mfma_f32_32x32x16_bf16 v[48:63], v[132:135], v[96:99], v[48:63]
    v_mfma_f32_32x32x16_bf16 v[64:79], v[132:135], v[100:103], v[64:79]
    s_waitcnt lgkmcnt(2)
    v_mfma_f32_32x32x16_bf16 v[16:31], v[136:139], v[104:107], v[16:31]
    v_mfma_f32_32x32x16_bf16 v[32:47], v[136:139], v[108:111], v[32:47]
    s_waitcnt lgkmcnt(0)
    v_mfma_f32_32x32x16_bf16 v[48:63], v[140:143], v[104:107], v[48:63]
    v_mfma_f32_32x32x16_bf16 v[64:79], v[140:143], v[108:111], v[64:79]
    s_nop 11
    v_mov_b32 v252, 159244
L_cnto_65:
    ds_read_b32 v254, v252
    s_waitcnt lgkmcnt(0)
    v_readfirstlane_b32 s92, v254
    s_nop 3
    s_cmp_lt_u32 s92, 8
    s_cbranch_scc1 L_cnto_65
    s_cmp_eq_u32 s53, 6
    s_cselect_b32 s49, 0, 129536
    v_add_u32 v13, s49, v3
    ds_write_b128 v13, v[16:19] offset:0
    ds_write_b128 v13, v[20:23] offset:1024
    ds_write_b128 v13, v[24:27] offset:2048
    ds_write_b128 v13, v[28:31] offset:3072
    ds_write_b128 v13, v[32:35] offset:4096
    ds_write_b128 v13, v[36:39] offset:5120
    ds_write_b128 v13, v[40:43] offset:6144
    ds_write_b128 v13, v[44:47] offset:7168
    ds_write_b128 v13, v[48:51] offset:8192
    ds_write_b128 v13, v[52:55] offset:9216
    ds_write_b128 v13, v[56:59] offset:10240
    ds_write_b128 v13, v[60:63] offset:11264
    ds_write_b128 v13, v[64:67] offset:12288
    ds_write_b128 v13, v[68:71] offset:13312
    ds_write_b128 v13, v[72:75] offset:14336
    ds_write_b128 v13, v[76:79] offset:15360
L_s3_join:
    v_and_b32 v7, 31, v0
    v_bfe_u32 v8, v0, 5, 2
    v_bfe_u32 v9, v0, 7, 1
    v_lshrrev_b32 v10, 8, v0
    s_lshl_b32 s49, s61, 6
    v_lshl_add_u32 v11, v10, 5, v7
    v_add_u32 v11, s49, v11
    v_mul_u32_u24 v11, 896, v11
    v_lshlrev_b32 v12, 5, v9
    v_lshl_add_u32 v12, v8, 3, v12
    s_lshl_b32 s49, s62, 7
    v_lshl_add_u32 v11, v12, 1, v11
    v_add_u32 v11, s49, v11
    buffer_load_dwordx4 v[244:247], v11, s[36:39], 0 offen
    s_waitcnt lgkmcnt(0)
    s_barrier
    v_lshlrev_b32 v13, 1, v9
    v_add_u32 v13, v13, v10
    v_lshl_add_u32 v13, v13, 2, v8
    v_lshlrev_b32 v13, 10, v13
    v_lshl_add_u32 v13, v7, 4, v13
    v_add_u32 v14, 24576, v13
    v_add_u32 v15, 73728, v13
    v_add_u32 v12, 129536, v13
    ds_read_b128 v[64:67], v14 offset:0
    ds_read_b128 v[68:71], v14 offset:512
    ds_read_b128 v[72:75], v14 offset:16384
    ds_read_b128 v[76:79], v14 offset:16896
    ds_read_b128 v[80:83], v14 offset:32768
    ds_read_b128 v[84:87], v14 offset:33280
    ds_read_b128 v[88:91], v15 offset:0
    ds_read_b128 v[92:95], v15 offset:512
    ds_read_b128 v[96:99], v15 offset:16384
    ds_read_b128 v[100:103], v15 offset:16896
    ds_read_b128 v[104:107], v15 offset:32768
    ds_read_b128 v[108:111], v15 offset:33280
    ds_read_b128 v[112:115], v13 offset:0
    ds_read_b128 v[116:119], v13 offset:512
    ds_read_b128 v[120:123], v12 offset:0
    ds_read_b128 v[124:127], v12 offset:512
    s_waitcnt lgkmcnt(12)
    v_add_f32 v32, v64, v72
    v_add_f32 v33, v65, v73
    v_add_f32 v34, v66, v74
    v_add_f32 v35, v67, v75
    v_add_f32 v36, v68, v76
    v_add_f32 v37, v69, v77
    v_add_f32 v38, v70, v78
    v_add_f32 v39, v71, v79
    s_waitcnt lgkmcnt(10)
    v_add_f32 v32, v32, v80
    v_add_f32 v33, v33, v81
    v_add_f32 v34, v34, v82
    v_add_f32 v35, v35, v83
    v_add_f32 v36, v36, v84
    v_add_f32 v37, v37, v85
    v_add_f32 v38, v38, v86
    v_add_f32 v39, v39, v87
    s_waitcnt lgkmcnt(8)
    v_add_f32 v32, v32, v88
    v_add_f32 v33, v33, v89
    v_add_f32 v34, v34, v90
    v_add_f32 v35, v35, v91
    v_add_f32 v36, v36, v92
    v_add_f32 v37, v37, v93
    v_add_f32 v38, v38, v94
    v_add_f32 v39, v39, v95
    s_waitcnt lgkmcnt(6)
    v_add_f32 v32, v32, v96
    v_add_f32 v33, v33, v97
    v_add_f32 v34, v34, v98
    v_add_f32 v35, v35, v99
    v_add_f32 v36, v36, v100
    v_add_f32 v37, v37, v101
    v_add_f32 v38, v38, v102
    v_add_f32 v39, v39, v103
    s_waitcnt lgkmcnt(4)
    v_add_f32 v32, v32, v104
    v_add_f32 v33, v33, v105
    v_add_f32 v34, v34, v106
    v_add_f32 v35, v35, v107
    v_add_f32 v36, v36, v108
    v_add_f32 v37, v37, v109
    v_add_f32 v38, v38, v110
    v_add_f32 v39, v39, v111
    s_waitcnt lgkmcnt(0)
    v_add_f32 v40, v112, v120
    v_add_f32 v41, v113, v121
    v_add_f32 v42, v114, v122
    v_add_f32 v43, v115, v123
    v_add_f32 v44, v116, v124
    v_add_f32 v45, v117, v125
    v_add_f32 v46, v118, v126
    v_add_f32 v47, v119, v127
    s_mov_b32 s58, 0xffff0000
    s_mov_b32 s59, 0xbfb8aa3b
    v_cvt_pk_bf16_f32 v48, v32, v33
    v_cvt_pk_bf16_f32 v52, v40, v41
    v_cvt_pk_bf16_f32 v49, v34, v35
    v_cvt_pk_bf16_f32 v53, v42, v43
    v_cvt_pk_bf16_f32 v50, v36, v37
    v_cvt_pk_bf16_f32 v54, v44, v45
    v_cvt_pk_bf16_f32 v51, v38, v39
    v_cvt_pk_bf16_f32 v55, v46, v47
    v_lshlrev_b32 v32, 16, v48
    v_and_b32 v33, s58, v48
    v_lshlrev_b32 v40, 16, v52
    v_and_b32 v41, s58, v52
    v_lshlrev_b32 v34, 16, v49
    v_and_b32 v35, s58, v49
    v_lshlrev_b32 v42, 16, v53
    v_and_b32 v43, s58, v53
    v_lshlrev_b32 v36, 16, v50
    v_and_b32 v37, s58, v50
    v_lshlrev_b32 v44, 16, v54
    v_and_b32 v45, s58, v54
    v_lshlrev_b32 v38, 16, v51
    v_and_b32 v39, s58, v51
    v_lshlrev_b32 v46, 16, v55
    v_and_b32 v47, s58, v55
    v_mul_f32 v48, s59, v32
    v_mul_f32 v49, s59, v33
    v_mul_f32 v50, s59, v34
    v_mul_f32 v51, s59, v35
    v_mul_f32 v52, s59, v36
    v_mul_f32 v53, s59, v37
    v_mul_f32 v54, s59, v38
    v_mul_f32 v55, s59, v39
    v_exp_f32 v48, v48
    v_exp_f32 v49, v49
    v_exp_f32 v50, v50
    v_exp_f32 v51, v51
    v_exp_f32 v52, v52
    v_exp_f32 v53, v53
    v_exp_f32 v54, v54
    v_exp_f32 v55, v55
    v_add_f32 v48, 1.0, v48
    v_add_f32 v49, 1.0, v49
    v_add_f32 v50, 1.0, v50
    v_add_f32 v51, 1.0, v51
    v_add_f32 v52, 1.0, v52
    v_add_f32 v53, 1.0, v53
    v_add_f32 v54, 1.0, v54
    v_add_f32 v55, 1.0, v55
    v_rcp_f32 v48, v48
    v_rcp_f32 v49, v49
    v_rcp_f32 v50, v50
    v_rcp_f32 v51, v51
    v_rcp_f32 v52, v52
    v_rcp_f32 v53, v53
    v_rcp_f32 v54, v54
    v_rcp_f32 v55, v55
    v_mul_f32 v32, v32, v48
    v_mul_f32 v33, v33, v49
    v_mul_f32 v34, v34, v50
    v_mul_f32 v35, v35, v51
    v_mul_f32 v36, v36, v52
    v_mul_f32 v37, v37, v53
    v_mul_f32 v38, v38, v54
    v_mul_f32 v39, v39, v55
    v_cvt_pk_bf16_f32 v48, v32, v33
    v_cvt_pk_bf16_f32 v49, v34, v35
    v_cvt_pk_bf16_f32 v50, v36, v37
    v_cvt_pk_bf16_f32 v51, v38, v39
    v_lshlrev_b32 v32, 16, v48
    v_and_b32 v33, s58, v48
    v_lshlrev_b32 v34, 16, v49
    v_and_b32 v35, s58, v49
    v_lshlrev_b32 v36, 16, v50
    v_and_b32 v37, s58, v50
    v_lshlrev_b32 v38, 16, v51
    v_and_b32 v39, s58, v51
    v_mul_f32 v32, v32, v40
    v_mul_f32 v33, v33, v41
    v_mul_f32 v34, v34, v42
    v_mul_f32 v35, v35, v43
    v_mul_f32 v36, v36, v44
    v_mul_f32 v37, v37, v45
    v_mul_f32 v38, v38, v46
    v_mul_f32 v39, v39, v47
    v_cvt_pk_bf16_f32 v48, v32, v33
    v_cvt_pk_bf16_f32 v49, v34, v35
    v_cvt_pk_bf16_f32 v50, v36, v37
    v_cvt_pk_bf16_f32 v51, v38, v39
    s_waitcnt vmcnt(0)
    v_lshlrev_b32 v32, 16, v48
    v_and_b32 v33, s58, v48
    v_lshlrev_b32 v40, 16, v244
    v_and_b32 v41, s58, v244
    v_lshlrev_b32 v34, 16, v49
    v_and_b32 v35, s58, v49
    v_lshlrev_b32 v42, 16, v245
    v_and_b32 v43, s58, v245
    v_lshlrev_b32 v36, 16, v50
    v_and_b32 v37, s58, v50
    v_lshlrev_b32 v44, 16, v246
    v_and_b32 v45, s58, v246
    v_lshlrev_b32 v38, 16, v51
    v_and_b32 v39, s58, v51
    v_lshlrev_b32 v46, 16, v247
    v_and_b32 v47, s58, v247
    v_add_f32 v32, v32, v40
    v_add_f32 v33, v33, v41
    v_add_f32 v34, v34, v42
    v_add_f32 v35, v35, v43
    v_add_f32 v36, v36, v44
    v_add_f32 v37, v37, v45
    v_add_f32 v38, v38, v46
    v_add_f32 v39, v39, v47
    v_cvt_pk_bf16_f32 v48, v32, v33
    v_cvt_pk_bf16_f32 v49, v34, v35
    v_cvt_pk_bf16_f32 v50, v36, v37
    v_cvt_pk_bf16_f32 v51, v38, v39
    buffer_store_dwordx4 v[48:51], v11, s[32:35], 0 offen
L_exit:
    s_endpgm
.p2align 10
L_code_end:
.section .rodata,"a"
.p2align 6
.amdhsa_kernel recurrent_scan__sliding_block__glu_gated_bilinear__prompt_kernel
  .amdhsa_next_free_vgpr 256
  .amdhsa_next_free_sgpr 102
  .amdhsa_accum_offset 256
  .amdhsa_group_segment_fixed_size 0
  .amdhsa_kernarg_size 80
  .amdhsa_user_sgpr_count 2
  .amdhsa_user_sgpr_kernarg_segment_ptr 1
  .amdhsa_system_sgpr_workgroup_id_x 1
.end_amdhsa_kernel
```
